```python
import torch

def _softmax(x, axis=-1):
    return torch.softmax(x, dim=axis)
def _gelu(x):
    return torch.nn.functional.gelu(x, approximate="tanh")
def _silu(x):
    return torch.nn.functional.silu(x)
def _sigmoid(x):
    return torch.sigmoid(x)
def _layernorm(x, axis=-1, eps=1e-5):
    m = x.mean(dim=axis, keepdim=True)
    v = x.var(dim=axis, keepdim=True, unbiased=False)
    return (x - m) / torch.sqrt(v + eps)
def _scatter_add(tgt, idx, src, axis=0):
    return tgt.clone().index_add_(axis, idx, src)
def _segment_sum(src, seg, n):
    out = torch.zeros((n,) + src.shape[1:], dtype=src.dtype)
    return out.index_add_(0, seg, src)
def _pad(x, pw):
    flat = tuple(v for pair in reversed(pw) for v in pair)
    return torch.nn.functional.pad(x, flat)

kernel_name = 'gather_scatter__edge_featured_mpnn_egc__graph'

def setup_inputs():

    _w = (lambda a: (lambda t: t.to(torch.bfloat16) if t.is_floating_point() else t)(torch.as_tensor(a)))
    N, deg, D, De = 12500, 64, 64, max(0, 1)
    E = N * deg
    return {
        "x": _w((lambda *s: torch.randn(*s, dtype=torch.bfloat16) * 0.2)(N, D)),
        "e_attr": _w((lambda *s: torch.randn(*s, dtype=torch.bfloat16) * 0.2)(E, De)),
        "src": _w((lambda lo, hi, *s: torch.randint(lo, hi, s))(0, N, E).to(torch.int64)),
        "dst": _w((lambda lo, hi, *s: torch.randint(lo, hi, s))(0, N, E).to(torch.int64)),
        "u_w": _w((lambda *s: torch.randn(*s, dtype=torch.bfloat16) * 0.05)(D, D)),
        "v_w": _w((lambda *s: torch.randn(*s, dtype=torch.bfloat16) * 0.05)(D, D)),
        "g_w": _w((lambda *s: torch.randn(*s, dtype=torch.bfloat16) * 0.2)(2 * D + De, D)),
    }

def reference(x, e_attr, src, dst, u_w, v_w, g_w):
    N, D = x.shape
    g_in = torch.concatenate([x[dst], x[src], e_attr], axis=-1)
    eta = _sigmoid(g_in @ g_w)
    hv = x @ v_w
    msg = eta * hv[src]
    agg = _segment_sum(msg, dst, N)
    return _silu(x @ u_w + agg)
```

```asm
; @launch kernel=k1_kernel grid=(241,1,1) block=(640,1,1) lds=85504
; @launch kernel=k2_kernel grid=(256,1,1) block=(1024,1,1) lds=147264
.amdgcn_target "amdgcn-amd-amdhsa--gfx950"
.text
.globl k1_kernel
.p2align 8
.type k1_kernel,@function
k1_kernel:
    s_cmp_gt_u32 s2, 240
    s_cbranch_scc1 K1_END
    s_load_dwordx16 s[16:31], s[0:1], 0
    s_load_dwordx2 s[32:33], s[0:1], 72
    v_lshrrev_b32 v1, 6, v0
    v_lshlrev_b32 v3, 4, v0
    v_readfirstlane_b32 s7, v1
    s_cmp_eq_u32 s2, 240
    s_cbranch_scc1 K1_FRAG
    s_cmp_lt_u32 s2, 160
    s_cbranch_scc1 K1_BIN
    s_cmp_ge_u32 s7, 8
    s_cbranch_scc1 K1_GEMM0
    s_sub_u32 s3, s2, 160
    s_and_b32 s8, s3, 7
    s_lshr_b32 s3, s3, 3
    s_mul_i32 s8, s8, 1568
    s_mul_i32 s3, s3, 160
    s_add_u32 s3, s3, s8
    s_lshl_b32 s12, s3, 7
    s_add_u32 s13, s12, 8192
    s_add_u32 s14, s12, 16384
    v_mov_b32 v108, v3
    s_cmp_ge_u32 s7, 4
    s_waitcnt lgkmcnt(0)
    s_mov_b32 s48, s16
    s_mov_b32 s50, 0x186a00
    s_mov_b32 s51, 0x20000
    s_cbranch_scc1 K1_GX
    s_and_b32 s49, s17, 0xffff
    buffer_load_dwordx4 v[24:27], v3, s[48:51], s14 offen nt
K1_GX:
    s_and_b32 s49, s17, 0xffff
    buffer_load_dwordx4 v[16:19], v3, s[48:51], s12 offen nt
    buffer_load_dwordx4 v[20:23], v3, s[48:51], s13 offen nt
    s_mov_b32 s36, s28
    s_and_b32 s37, s29, 0xffff
    s_mov_b32 s38, 0x4080
    s_mov_b32 s39, 0x20000
    s_movk_i32 s10, 0x2000
    buffer_load_dwordx4 v[8:11], v108, s[36:39], s10 offen
    s_mov_b32 s40, s26
    s_and_b32 s41, s27, 0xffff
    s_mov_b32 s42, 0x2000
    s_mov_b32 s43, 0x20000
    buffer_load_dwordx4 v[12:15], v108, s[40:43], 0 offen
    s_branch K1_GEMM
K1_BIN:
    s_mov_b32 s34, s2
    v_lshlrev_b32 v4, 3, v0
    s_mul_i32 s3, s34, 20000
    s_add_u32 s4, s3, 10000
    s_mul_i32 s5, s34, 10000
    s_add_u32 s6, s5, 5000
    v_cmp_gt_u32 vcc, 625, v0
    v_and_b32 v1, 0xff, v0
    v_mul_u32_u24 v2, 51, v1
    v_lshlrev_b32 v1, 2, v1
    s_mov_b64 s[8:9], vcc
    ds_write_b32 v1, v2
    s_movk_i32 s10, -49
    v_mov_b32 v5, 1
    s_waitcnt lgkmcnt(0)
    s_mov_b32 s36, s22
    s_and_b32 s37, s23, 0xffff
    s_mov_b32 s38, 0x30d400
    s_mov_b32 s39, 0x20000
    s_mov_b64 exec, s[8:9]
    buffer_load_dwordx4 v[8:11], v3, s[36:39], s3 offen nt
    buffer_load_dwordx4 v[12:15], v3, s[36:39], s4 offen nt
    s_mov_b32 s40, s20
    s_and_b32 s41, s21, 0xffff
    s_mov_b32 s42, 0x30d400
    s_mov_b32 s43, 0x20000
    s_mov_b32 s44, s18
    s_and_b32 s45, s19, 0xffff
    s_mov_b32 s46, 0x186a00
    s_mov_b32 s47, 0x20000
    s_barrier
    buffer_load_dwordx4 v[16:19], v3, s[40:43], s3 offen nt
    buffer_load_dwordx2 v[24:25], v4, s[44:47], s5 offen nt
    buffer_load_dwordx4 v[20:23], v3, s[40:43], s4 offen nt
    buffer_load_dwordx2 v[26:27], v4, s[44:47], s6 offen nt
    s_mov_b64 exec, -1
    s_add_u32 s48, s32, 0x800000
    s_addc_u32 s49, s33, 0
    s_and_b32 s49, s49, 0xffff
    s_mov_b32 s50, 0x47e000
    s_mov_b32 s51, 0x20000
    s_add_u32 s52, s32, 0x1000000
    s_addc_u32 s53, s33, 0
    s_and_b32 s53, s53, 0xffff
    s_mov_b32 s54, 0x40000
    s_mov_b32 s55, 0x20000
    v_lshlrev_b32 v6, 2, v0
    v_add_u32 v6, 70784, v6
    v_mov_b32 v2, 0
    ds_write_b32 v6, v2 offset:0
    ds_write_b32 v6, v2 offset:2560
    ds_write_b32 v6, v2 offset:5120
    v_and_b32 v1, 63, v0
    v_mul_u32_u24 v84, 204, v1
    v_mul_u32_u24 v88, 1088, v1
    s_lshl_b32 s56, s7, 4
    s_add_u32 s56, s56, 1024
    v_add_u32 v88, s56, v88
    v_add_u32 v85, 51, v84
    v_add_u32 v89, 272, v88
    v_add_u32 v86, 102, v84
    v_add_u32 v90, 544, v88
    v_add_u32 v87, 153, v84
    v_add_u32 v91, 816, v88
    v_lshlrev_b32 v1, 4, v1
    s_mul_i32 s57, s7, 3
    s_add_u32 s58, s57, 30
    s_add_u32 s56, s7, 17696
    s_mov_b32 s11, 0xffff0000
    s_movk_i32 s13, 21846
    s_movk_i32 s59, 13056
    s_mov_b64 exec, s[8:9]
    s_waitcnt vmcnt(5)
    v_mul_u32_u24 v28, 5350, v8
    v_lshrrev_b32 v60, 18, v28
    v_lshlrev_b32 v28, 2, v60
    ds_add_rtn_u32 v36, v28, v5
    v_lshlrev_b32 v8, 2, v8
    v_mad_i32_i24 v8, v28, s10, v8
    v_mul_u32_u24 v29, 5350, v9
    v_lshrrev_b32 v61, 18, v29
    v_lshlrev_b32 v29, 2, v61
    ds_add_rtn_u32 v37, v29, v5
    v_lshlrev_b32 v9, 2, v9
    v_mad_i32_i24 v9, v29, s10, v9
    v_mul_u32_u24 v30, 5350, v10
    v_lshrrev_b32 v62, 18, v30
    v_lshlrev_b32 v30, 2, v62
    ds_add_rtn_u32 v38, v30, v5
    v_lshlrev_b32 v10, 2, v10
    v_mad_i32_i24 v10, v30, s10, v10
    v_mul_u32_u24 v31, 5350, v11
    v_lshrrev_b32 v63, 18, v31
    v_lshlrev_b32 v31, 2, v63
    ds_add_rtn_u32 v39, v31, v5
    v_lshlrev_b32 v11, 2, v11
    v_mad_i32_i24 v11, v31, s10, v11
    s_waitcnt vmcnt(4)
    v_mul_u32_u24 v32, 5350, v12
    v_lshrrev_b32 v64, 18, v32
    v_lshlrev_b32 v32, 2, v64
    ds_add_rtn_u32 v40, v32, v5
    v_lshlrev_b32 v12, 2, v12
    v_mad_i32_i24 v12, v32, s10, v12
    v_mul_u32_u24 v33, 5350, v13
    v_lshrrev_b32 v65, 18, v33
    v_lshlrev_b32 v33, 2, v65
    ds_add_rtn_u32 v41, v33, v5
    v_lshlrev_b32 v13, 2, v13
    v_mad_i32_i24 v13, v33, s10, v13
    v_mul_u32_u24 v34, 5350, v14
    v_lshrrev_b32 v66, 18, v34
    v_lshlrev_b32 v34, 2, v66
    ds_add_rtn_u32 v42, v34, v5
    v_lshlrev_b32 v14, 2, v14
    v_mad_i32_i24 v14, v34, s10, v14
    v_mul_u32_u24 v35, 5350, v15
    v_lshrrev_b32 v67, 18, v35
    v_lshlrev_b32 v35, 2, v67
    ds_add_rtn_u32 v43, v35, v5
    v_lshlrev_b32 v15, 2, v15
    v_mad_i32_i24 v15, v35, s10, v15
    s_waitcnt lgkmcnt(7)
    v_min_u32 v36, s59, v36
    v_mul_u32_u24 v44, s13, v36
    v_lshrrev_b32 v44, 16, v44
    v_mad_u32_u24 v52, v44, 13, v36
    ds_write_b8 v52, v8 offset:1036
    v_add_lshl_u32 v44, v44, v36, 2
    s_waitcnt lgkmcnt(7)
    v_min_u32 v37, s59, v37
    v_mul_u32_u24 v45, s13, v37
    v_lshrrev_b32 v45, 16, v45
    v_mad_u32_u24 v53, v45, 13, v37
    ds_write_b8 v53, v9 offset:1036
    v_add_lshl_u32 v45, v45, v37, 2
    s_waitcnt lgkmcnt(7)
    v_min_u32 v38, s59, v38
    v_mul_u32_u24 v46, s13, v38
    v_lshrrev_b32 v46, 16, v46
    v_mad_u32_u24 v54, v46, 13, v38
    ds_write_b8 v54, v10 offset:1036
    v_add_lshl_u32 v46, v46, v38, 2
    s_waitcnt lgkmcnt(7)
    v_min_u32 v39, s59, v39
    v_mul_u32_u24 v47, s13, v39
    v_lshrrev_b32 v47, 16, v47
    v_mad_u32_u24 v55, v47, 13, v39
    ds_write_b8 v55, v11 offset:1036
    v_add_lshl_u32 v47, v47, v39, 2
    s_waitcnt lgkmcnt(7)
    v_min_u32 v40, s59, v40
    v_mul_u32_u24 v48, s13, v40
    v_lshrrev_b32 v48, 16, v48
    v_mad_u32_u24 v56, v48, 13, v40
    ds_write_b8 v56, v12 offset:1036
    v_add_lshl_u32 v48, v48, v40, 2
    s_waitcnt lgkmcnt(7)
    v_min_u32 v41, s59, v41
    v_mul_u32_u24 v49, s13, v41
    v_lshrrev_b32 v49, 16, v49
    v_mad_u32_u24 v57, v49, 13, v41
    ds_write_b8 v57, v13 offset:1036
    v_add_lshl_u32 v49, v49, v41, 2
    s_waitcnt lgkmcnt(7)
    v_min_u32 v42, s59, v42
    v_mul_u32_u24 v50, s13, v42
    v_lshrrev_b32 v50, 16, v50
    v_mad_u32_u24 v58, v50, 13, v42
    ds_write_b8 v58, v14 offset:1036
    v_add_lshl_u32 v50, v50, v42, 2
    s_waitcnt lgkmcnt(7)
    v_min_u32 v43, s59, v43
    v_mul_u32_u24 v51, s13, v43
    v_lshrrev_b32 v51, 16, v51
    v_mad_u32_u24 v59, v51, 13, v43
    ds_write_b8 v59, v15 offset:1036
    v_add_lshl_u32 v51, v51, v43, 2
    s_mov_b64 exec, -1
    s_barrier
    ds_read_b128 v[60:63], v1 offset:0
    s_waitcnt lgkmcnt(0)
    v_sub_u32 v60, v60, v84
    v_sub_u32 v61, v61, v85
    v_sub_u32 v62, v62, v86
    v_sub_u32 v63, v63, v87
    v_add_u32 v80, 2, v60
    v_add_u32 v81, 2, v61
    v_add_u32 v82, 2, v62
    v_add_u32 v83, 2, v63
    v_mul_u32_u24 v80, s13, v80
    v_mul_u32_u24 v81, s13, v81
    v_mul_u32_u24 v82, s13, v82
    v_mul_u32_u24 v83, s13, v83
    v_lshrrev_b32 v80, 16, v80
    v_lshrrev_b32 v81, 16, v81
    v_lshrrev_b32 v82, 16, v82
    v_lshrrev_b32 v83, 16, v83
    v_add_u32 v65, v80, v81
    v_add_u32 v66, v65, v82
    v_add_u32 v67, v66, v83
    v_max_u32 v64, v60, v61
    v_mov_b32 v68, v67
    v_max3_u32 v64, v64, v62, v63
    s_nop 1
    v_add_u32_dpp v68, v68, v68 row_shr:1 row_mask:0xf bank_mask:0xf
    s_nop 1
    v_add_u32_dpp v68, v68, v68 row_shr:2 row_mask:0xf bank_mask:0xf
    s_nop 1
    v_add_u32_dpp v68, v68, v68 row_shr:4 row_mask:0xf bank_mask:0xf
    s_nop 1
    v_add_u32_dpp v68, v68, v68 row_shr:8 row_mask:0xf bank_mask:0xf
    s_nop 1
    v_add_u32_dpp v68, v68, v68 row_bcast:15 row_mask:0xa bank_mask:0xf
    s_nop 1
    v_add_u32_dpp v68, v68, v68 row_bcast:31 row_mask:0xc bank_mask:0xf
    v_cmp_lt_u32 vcc, 48, v64
    v_readlane_b32 s14, v68, 63
    v_sub_u32 v68, v68, v67
    s_cbranch_vccnz K1_SLOW
    v_add_u32 v69, v68, v80
    v_add_u32 v70, v68, v65
    v_add_u32 v71, v68, v66
    v_add_lshl_u32 v72, v68, s56, 2
    v_add_lshl_u32 v73, v69, s56, 2
    v_add_lshl_u32 v74, v70, s56, 2
    v_add_lshl_u32 v75, v71, s56, 2
    v_cmpx_lt_u32 vcc, s57, v60
    ds_write_b32 v72, v88
    s_mov_b64 exec, -1
    v_cmpx_lt_u32 vcc, s57, v61
    ds_write_b32 v73, v89
    s_mov_b64 exec, -1
    v_cmpx_lt_u32 vcc, s57, v62
    ds_write_b32 v74, v90
    s_mov_b64 exec, -1
    v_cmpx_lt_u32 vcc, s57, v63
    ds_write_b32 v75, v91
    s_mov_b64 exec, -1
    v_cmp_lt_u32 vcc, s58, v64
    v_lshl_or_b32 v76, v68, 16, v60
    v_lshl_or_b32 v77, v69, 16, v61
    v_lshl_or_b32 v78, v70, 16, v62
    v_lshl_or_b32 v79, v71, 16, v63
    s_cbranch_vccz K1_NOM2
    v_cmpx_lt_u32 vcc, s58, v60
    v_add_u32 v88, 160, v88
    ds_write_b32 v72, v88 offset:40
    s_mov_b64 exec, -1
    v_cmpx_lt_u32 vcc, s58, v61
    v_add_u32 v89, 160, v89
    ds_write_b32 v73, v89 offset:40
    s_mov_b64 exec, -1
    v_cmpx_lt_u32 vcc, s58, v62
    v_add_u32 v90, 160, v90
    ds_write_b32 v74, v90 offset:40
    s_mov_b64 exec, -1
    v_cmpx_lt_u32 vcc, s58, v63
    v_add_u32 v91, 160, v91
    ds_write_b32 v75, v91 offset:40
    s_mov_b64 exec, -1
K1_NOM2:
    s_add_u32 s14, s14, 7
    s_and_b32 s14, s14, -8
    s_lshl_b32 s14, s14, 4
    s_sub_u32 s14, s14, 20480
    v_cmp_gt_i32 vcc, s14, v3
    s_mul_i32 s12, s34, 29440
    s_add_u32 s13, s12, 10240
    s_add_u32 s14, s12, 20480
    v_cndmask_b32 v7, 0.5, v3, vcc
    s_mov_b64 exec, s[8:9]
    s_waitcnt vmcnt(2)
    v_lshl_or_b32 v16, v24, 16, v16
    v_and_or_b32 v17, v24, s11, v17
    v_lshl_or_b32 v18, v25, 16, v18
    v_and_or_b32 v19, v25, s11, v19
    ds_write_b32 v44, v16 offset:1024
    ds_write_b32 v45, v17 offset:1024
    ds_write_b32 v46, v18 offset:1024
    ds_write_b32 v47, v19 offset:1024
    s_waitcnt vmcnt(0)
    v_lshl_or_b32 v20, v26, 16, v20
    v_and_or_b32 v21, v26, s11, v21
    v_lshl_or_b32 v22, v27, 16, v22
    v_and_or_b32 v23, v27, s11, v23
    ds_write_b32 v48, v20 offset:1024
    ds_write_b32 v49, v21 offset:1024
    ds_write_b32 v50, v22 offset:1024
    ds_write_b32 v51, v23 offset:1024
    s_mov_b64 exec, -1
    s_cmp_lg_u32 s7, 0
    s_cbranch_scc1 K1_NOOFF2
    s_lshl_b32 s15, s34, 6
    v_lshrrev_b32 v2, 6, v1
    v_and_b32 v80, 63, v1
    v_lshl_or_b32 v2, v2, 14, v80
    buffer_store_dwordx4 v[76:79], v2, s[52:55], s15 offen sc1
K1_NOOFF2:
    s_waitcnt lgkmcnt(0)
    s_barrier
    ds_read_b32 v28, v6 offset:0
    ds_read_b32 v29, v6 offset:2560
    ds_read_b32 v30, v6 offset:5120
    s_waitcnt lgkmcnt(2)
    ds_read_b128 v[8:11], v28
    s_waitcnt lgkmcnt(2)
    ds_read_b128 v[12:15], v29
    s_waitcnt lgkmcnt(2)
    ds_read_b128 v[16:19], v30
    s_waitcnt lgkmcnt(2)
    buffer_store_dwordx4 v[8:11], v3, s[48:51], s12 offen sc1
    s_waitcnt lgkmcnt(1)
    buffer_store_dwordx4 v[12:15], v3, s[48:51], s13 offen sc1
    s_waitcnt lgkmcnt(0)
    buffer_store_dwordx4 v[16:19], v7, s[48:51], s14 offen sc1
    s_endpgm
K1_SLOW:
    s_waitcnt vmcnt(0) lgkmcnt(0)
    s_barrier
    v_and_b32 v1, 0xff, v0
    v_lshlrev_b32 v1, 2, v1
    v_mov_b32 v2, 0
    ds_write_b32 v1, v2
    v_lshlrev_b32 v4, 3, v0
    s_mul_i32 s3, s34, 20000
    s_add_u32 s4, s3, 10000
    s_mul_i32 s5, s34, 10000
    s_add_u32 s6, s5, 5000
    v_cmp_gt_u32 vcc, 625, v0
    s_movk_i32 s10, -49
    v_mov_b32 v5, 1
    s_waitcnt lgkmcnt(0)
    s_mov_b32 s36, s22
    s_and_b32 s37, s23, 0xffff
    s_mov_b32 s38, 0x30d400
    s_mov_b32 s39, 0x20000
    s_mov_b64 s[8:9], vcc
    s_mov_b64 exec, vcc
    buffer_load_dwordx4 v[8:11], v3, s[36:39], s3 offen nt
    buffer_load_dwordx4 v[12:15], v3, s[36:39], s4 offen nt
    s_mov_b32 s40, s20
    s_and_b32 s41, s21, 0xffff
    s_mov_b32 s42, 0x30d400
    s_mov_b32 s43, 0x20000
    s_mov_b32 s44, s18
    s_and_b32 s45, s19, 0xffff
    s_mov_b32 s46, 0x186a00
    s_mov_b32 s47, 0x20000
    s_barrier
    buffer_load_dwordx4 v[16:19], v3, s[40:43], s3 offen nt
    buffer_load_dwordx2 v[24:25], v4, s[44:47], s5 offen nt
    buffer_load_dwordx4 v[20:23], v3, s[40:43], s4 offen nt
    buffer_load_dwordx2 v[26:27], v4, s[44:47], s6 offen nt
    s_add_u32 s48, s32, 0x800000
    s_addc_u32 s49, s33, 0
    s_and_b32 s49, s49, 0xffff
    s_mov_b32 s50, 0x47e000
    s_mov_b32 s51, 0x20000
    s_add_u32 s52, s32, 0x1000000
    s_addc_u32 s53, s33, 0
    s_and_b32 s53, s53, 0xffff
    s_mov_b32 s54, 0x40000
    s_mov_b32 s55, 0x20000
    s_waitcnt vmcnt(5)
    v_mul_u32_u24 v28, 5350, v8
    v_lshrrev_b32 v60, 18, v28
    v_lshlrev_b32 v28, 2, v60
    ds_add_rtn_u32 v36, v28, v5
    v_lshlrev_b32 v8, 2, v8
    v_mad_i32_i24 v8, v28, s10, v8
    v_mul_u32_u24 v29, 5350, v9
    v_lshrrev_b32 v61, 18, v29
    v_lshlrev_b32 v29, 2, v61
    ds_add_rtn_u32 v37, v29, v5
    v_lshlrev_b32 v9, 2, v9
    v_mad_i32_i24 v9, v29, s10, v9
    v_mul_u32_u24 v30, 5350, v10
    v_lshrrev_b32 v62, 18, v30
    v_lshlrev_b32 v30, 2, v62
    ds_add_rtn_u32 v38, v30, v5
    v_lshlrev_b32 v10, 2, v10
    v_mad_i32_i24 v10, v30, s10, v10
    v_mul_u32_u24 v31, 5350, v11
    v_lshrrev_b32 v63, 18, v31
    v_lshlrev_b32 v31, 2, v63
    ds_add_rtn_u32 v39, v31, v5
    v_lshlrev_b32 v11, 2, v11
    v_mad_i32_i24 v11, v31, s10, v11
    s_waitcnt vmcnt(4)
    v_mul_u32_u24 v32, 5350, v12
    v_lshrrev_b32 v64, 18, v32
    v_lshlrev_b32 v32, 2, v64
    ds_add_rtn_u32 v40, v32, v5
    v_lshlrev_b32 v12, 2, v12
    v_mad_i32_i24 v12, v32, s10, v12
    v_mul_u32_u24 v33, 5350, v13
    v_lshrrev_b32 v65, 18, v33
    v_lshlrev_b32 v33, 2, v65
    ds_add_rtn_u32 v41, v33, v5
    v_lshlrev_b32 v13, 2, v13
    v_mad_i32_i24 v13, v33, s10, v13
    v_mul_u32_u24 v34, 5350, v14
    v_lshrrev_b32 v66, 18, v34
    v_lshlrev_b32 v34, 2, v66
    ds_add_rtn_u32 v42, v34, v5
    v_lshlrev_b32 v14, 2, v14
    v_mad_i32_i24 v14, v34, s10, v14
    v_mul_u32_u24 v35, 5350, v15
    v_lshrrev_b32 v67, 18, v35
    v_lshlrev_b32 v35, 2, v67
    ds_add_rtn_u32 v43, v35, v5
    v_lshlrev_b32 v15, 2, v15
    v_mad_i32_i24 v15, v35, s10, v15
    s_mov_b32 s11, 0xffff0000
    s_movk_i32 s13, 21846
    s_waitcnt lgkmcnt(7)
    v_mul_u32_u24 v44, s13, v36
    v_lshrrev_b32 v44, 16, v44
    v_mad_u32_u24 v52, v44, 13, v36
    v_add_u32 v44, v44, v36
    s_waitcnt lgkmcnt(6)
    v_mul_u32_u24 v45, s13, v37
    v_lshrrev_b32 v45, 16, v45
    v_mad_u32_u24 v53, v45, 13, v37
    v_add_u32 v45, v45, v37
    s_waitcnt lgkmcnt(5)
    v_mul_u32_u24 v46, s13, v38
    v_lshrrev_b32 v46, 16, v46
    v_mad_u32_u24 v54, v46, 13, v38
    v_add_u32 v46, v46, v38
    s_waitcnt lgkmcnt(4)
    v_mul_u32_u24 v47, s13, v39
    v_lshrrev_b32 v47, 16, v47
    v_mad_u32_u24 v55, v47, 13, v39
    v_add_u32 v47, v47, v39
    s_waitcnt lgkmcnt(3)
    v_mul_u32_u24 v48, s13, v40
    v_lshrrev_b32 v48, 16, v48
    v_mad_u32_u24 v56, v48, 13, v40
    v_add_u32 v48, v48, v40
    s_waitcnt lgkmcnt(2)
    v_mul_u32_u24 v49, s13, v41
    v_lshrrev_b32 v49, 16, v49
    v_mad_u32_u24 v57, v49, 13, v41
    v_add_u32 v49, v49, v41
    s_waitcnt lgkmcnt(1)
    v_mul_u32_u24 v50, s13, v42
    v_lshrrev_b32 v50, 16, v50
    v_mad_u32_u24 v58, v50, 13, v42
    v_add_u32 v50, v50, v42
    s_waitcnt lgkmcnt(0)
    v_mul_u32_u24 v51, s13, v43
    v_lshrrev_b32 v51, 16, v51
    v_mad_u32_u24 v59, v51, 13, v43
    v_add_u32 v51, v51, v43
    s_barrier
    s_mov_b64 exec, -1
    v_and_b32 v1, 63, v0
    v_lshlrev_b32 v1, 4, v1
    ds_read_b128 v[60:63], v1 offset:0
    s_waitcnt lgkmcnt(0)
    v_add_u32 v80, 2, v60
    v_add_u32 v81, 2, v61
    v_add_u32 v82, 2, v62
    v_add_u32 v83, 2, v63
    v_mul_u32_u24 v80, s13, v80
    v_mul_u32_u24 v81, s13, v81
    v_mul_u32_u24 v82, s13, v82
    v_mul_u32_u24 v83, s13, v83
    v_lshrrev_b32 v80, 16, v80
    v_lshrrev_b32 v81, 16, v81
    v_lshrrev_b32 v82, 16, v82
    v_lshrrev_b32 v83, 16, v83
    v_add_u32 v65, v80, v81
    v_add_u32 v66, v65, v82
    v_add_u32 v67, v66, v83
    v_mov_b32 v68, v67
    s_nop 1
    v_add_u32_dpp v68, v68, v68 row_shr:1 row_mask:0xf bank_mask:0xf
    s_nop 1
    v_add_u32_dpp v68, v68, v68 row_shr:2 row_mask:0xf bank_mask:0xf
    s_nop 1
    v_add_u32_dpp v68, v68, v68 row_shr:4 row_mask:0xf bank_mask:0xf
    s_nop 1
    v_add_u32_dpp v68, v68, v68 row_shr:8 row_mask:0xf bank_mask:0xf
    s_nop 1
    v_add_u32_dpp v68, v68, v68 row_bcast:15 row_mask:0xa bank_mask:0xf
    s_nop 1
    v_add_u32_dpp v68, v68, v68 row_bcast:31 row_mask:0xc bank_mask:0xf
    s_nop 0
    v_readlane_b32 s14, v68, 63
    v_sub_u32 v68, v68, v67
    v_add_u32 v69, v68, v80
    v_add_u32 v70, v68, v65
    v_add_u32 v71, v68, v66
    v_mov_b32 v6, 2048
    v_lshl_add_u32 v72, v68, 4, v6
    v_lshl_add_u32 v73, v69, 4, v6
    v_lshl_add_u32 v74, v70, 4, v6
    v_lshl_add_u32 v75, v71, 4, v6
    ds_write_b128 v1, v[72:75] offset:1024
    v_lshl_or_b32 v76, v68, 16, v60
    v_lshl_or_b32 v77, v69, 16, v61
    v_lshl_or_b32 v78, v70, 16, v62
    v_lshl_or_b32 v79, v71, 16, v63
    s_add_u32 s14, s14, 7
    s_and_b32 s14, s14, -8
    s_lshl_b32 s14, s14, 4
    s_sub_u32 s14, s14, 20480
    v_cmp_gt_u32 vcc, s14, v3
    s_waitcnt lgkmcnt(0)
    s_nop 0
    v_cndmask_b32 v7, 0.5, v3, vcc
    s_mov_b64 exec, s[8:9]
    ds_read_b32 v60, v28 offset:1024
    ds_read_b32 v61, v29 offset:1024
    ds_read_b32 v62, v30 offset:1024
    ds_read_b32 v63, v31 offset:1024
    ds_read_b32 v64, v32 offset:1024
    ds_read_b32 v65, v33 offset:1024
    ds_read_b32 v66, v34 offset:1024
    ds_read_b32 v67, v35 offset:1024
    s_waitcnt lgkmcnt(7)
    v_add_u32 v52, v52, v60
    ds_write_b8 v52, v8 offset:12
    v_lshl_add_u32 v44, v44, 2, v60
    s_waitcnt lgkmcnt(7)
    v_add_u32 v53, v53, v61
    ds_write_b8 v53, v9 offset:12
    v_lshl_add_u32 v45, v45, 2, v61
    s_waitcnt lgkmcnt(7)
    v_add_u32 v54, v54, v62
    ds_write_b8 v54, v10 offset:12
    v_lshl_add_u32 v46, v46, 2, v62
    s_waitcnt lgkmcnt(7)
    v_add_u32 v55, v55, v63
    ds_write_b8 v55, v11 offset:12
    v_lshl_add_u32 v47, v47, 2, v63
    s_waitcnt lgkmcnt(7)
    v_add_u32 v56, v56, v64
    ds_write_b8 v56, v12 offset:12
    v_lshl_add_u32 v48, v48, 2, v64
    s_waitcnt lgkmcnt(7)
    v_add_u32 v57, v57, v65
    ds_write_b8 v57, v13 offset:12
    v_lshl_add_u32 v49, v49, 2, v65
    s_waitcnt lgkmcnt(7)
    v_add_u32 v58, v58, v66
    ds_write_b8 v58, v14 offset:12
    v_lshl_add_u32 v50, v50, 2, v66
    s_waitcnt lgkmcnt(7)
    v_add_u32 v59, v59, v67
    ds_write_b8 v59, v15 offset:12
    v_lshl_add_u32 v51, v51, 2, v67
    s_waitcnt vmcnt(2)
    v_lshl_or_b32 v16, v24, 16, v16
    v_and_or_b32 v17, v24, s11, v17
    v_lshl_or_b32 v18, v25, 16, v18
    v_and_or_b32 v19, v25, s11, v19
    ds_write_b32 v44, v16
    ds_write_b32 v45, v17
    ds_write_b32 v46, v18
    ds_write_b32 v47, v19
    s_waitcnt vmcnt(0)
    v_lshl_or_b32 v20, v26, 16, v20
    v_and_or_b32 v21, v26, s11, v21
    v_lshl_or_b32 v22, v27, 16, v22
    v_and_or_b32 v23, v27, s11, v23
    ds_write_b32 v48, v20
    ds_write_b32 v49, v21
    ds_write_b32 v50, v22
    ds_write_b32 v51, v23
    s_mov_b64 exec, -1
    s_cmp_lg_u32 s7, 9
    s_cbranch_scc1 K1_NOOFF
    s_lshl_b32 s12, s34, 6
    v_lshrrev_b32 v2, 6, v1
    v_and_b32 v80, 63, v1
    v_lshl_or_b32 v2, v2, 14, v80
    buffer_store_dwordx4 v[76:79], v2, s[52:55], s12 offen sc1
K1_NOOFF:
    s_mul_i32 s12, s34, 29440
    s_add_u32 s13, s12, 10240
    s_add_u32 s14, s12, 20480
    s_mov_b64 exec, -1
    s_waitcnt lgkmcnt(0)
    s_barrier
    ds_read_b128 v[8:11], v3 offset:2048
    ds_read_b128 v[12:15], v3 offset:12288
    ds_read_b128 v[16:19], v3 offset:22528
    s_waitcnt lgkmcnt(2)
    buffer_store_dwordx4 v[8:11], v3, s[48:51], s12 offen sc1
    s_waitcnt lgkmcnt(1)
    buffer_store_dwordx4 v[12:15], v3, s[48:51], s13 offen sc1
    s_waitcnt lgkmcnt(0)
    buffer_store_dwordx4 v[16:19], v7, s[48:51], s14 offen sc1
    s_endpgm
K1_GEND:
    s_endpgm
K1_GEMM0:
    s_cmp_ge_u32 s2, 232
    s_cbranch_scc1 K1_GEND
    s_sub_u32 s3, s2, 160
    s_and_b32 s8, s3, 7
    s_lshr_b32 s3, s3, 3
    s_mul_i32 s8, s8, 1568
    s_mul_i32 s3, s3, 160
    s_add_u32 s3, s3, s8
    s_waitcnt lgkmcnt(0)
K1_GEMM:
    s_and_b32 s6, s7, 1
    s_lshr_b32 s4, s7, 1
    v_and_b32 v1, 63, v0
    v_and_b32 v2, 31, v1
    v_lshrrev_b32 v4, 5, v1
    s_lshl_b32 s9, s4, 5
    s_add_u32 s8, s3, s9
    v_add_u32 v2, s9, v2
    v_mul_u32_u24 v5, 144, v2
    v_lshl_add_u32 v5, v4, 4, v5
    v_lshrrev_b32 v107, 3, v0
    v_mul_u32_u24 v107, 144, v107
    v_and_b32 v7, 7, v0
    v_lshl_add_u32 v107, v7, 4, v107
    v_add_u32 v107, 62464, v107
    s_mov_b32 s52, s32
    s_and_b32 s53, s33, 0xffff
    s_mov_b32 s54, 0x30d400
    s_mov_b32 s55, 0x20000
    v_bfe_u32 v6, v1, 2, 2
    v_lshl_add_u32 v6, v4, 3, v6
    v_lshlrev_b32 v6, 7, v6
    v_and_b32 v7, 1, v1
    v_lshl_add_u32 v6, v7, 5, v6
    v_bfe_u32 v7, v1, 4, 1
    v_lshl_add_u32 v6, v7, 4, v6
    v_bfe_u32 v7, v1, 1, 1
    v_lshl_add_u32 v6, v7, 3, v6
    s_lshl_b32 s11, s6, 6
    v_add_u32 v6, s11, v6
    s_mul_i32 s11, s7, 4608
    s_add_u32 s11, s11, 16384
    v_and_b32 v104, 31, v1
    v_mul_u32_u24 v104, 144, v104
    v_lshl_add_u32 v104, v4, 6, v104
    v_add_u32 v104, s11, v104
    v_lshrrev_b32 v105, 3, v1
    v_and_b32 v106, 7, v1
    v_lshlrev_b32 v106, 4, v106
    v_add_u32 v2, s8, v105
    v_mul_u32_u24 v105, 144, v105
    v_add3_u32 v105, v105, v106, s11
    v_lshl_add_u32 v2, v2, 8, v106
    s_lshl_b32 s11, s6, 7
    v_add_u32 v2, s11, v2
    s_cmp_ge_u32 s7, 8
    s_cbranch_scc1 K1_GW
    s_cmp_ge_u32 s7, 4
    s_cbranch_scc1 K1_GX2
    s_waitcnt vmcnt(4)
    ds_write_b128 v107, v[24:27] offset:18432
K1_GX2:
    s_waitcnt vmcnt(3)
    ds_write_b128 v107, v[16:19] offset:0
    s_waitcnt vmcnt(2)
    ds_write_b128 v107, v[20:23] offset:9216
    s_waitcnt vmcnt(1)
    ds_write_b128 v108, v[8:11] offset:0
    s_waitcnt vmcnt(0)
    ds_write_b128 v108, v[12:15] offset:8192
    s_waitcnt lgkmcnt(0)
K1_GW:
    s_barrier
    ds_read_b128 v[24:27], v5 offset:62464
    ds_read_b128 v[28:31], v5 offset:62496
    ds_read_b128 v[32:35], v5 offset:62528
    ds_read_b128 v[36:39], v5 offset:62560
    ds_read_b64_tr_b16 v[40:41], v6 offset:0
    ds_read_b64_tr_b16 v[42:43], v6 offset:512
    ds_read_b64_tr_b16 v[56:57], v6 offset:8192
    ds_read_b64_tr_b16 v[58:59], v6 offset:8704
    ds_read_b64_tr_b16 v[44:45], v6 offset:2048
    ds_read_b64_tr_b16 v[46:47], v6 offset:2560
    ds_read_b64_tr_b16 v[60:61], v6 offset:10240
    ds_read_b64_tr_b16 v[62:63], v6 offset:10752
    ds_read_b64_tr_b16 v[48:49], v6 offset:4096
    ds_read_b64_tr_b16 v[50:51], v6 offset:4608
    ds_read_b64_tr_b16 v[64:65], v6 offset:12288
    ds_read_b64_tr_b16 v[66:67], v6 offset:12800
    ds_read_b64_tr_b16 v[52:53], v6 offset:6144
    ds_read_b64_tr_b16 v[54:55], v6 offset:6656
    ds_read_b64_tr_b16 v[68:69], v6 offset:14336
    ds_read_b64_tr_b16 v[70:71], v6 offset:14848
    s_waitcnt lgkmcnt(14)
    v_mfma_f32_32x32x16_bf16 v[72:87], v[40:43], v[24:27], 0
    s_waitcnt lgkmcnt(12)
    v_mfma_f32_32x32x16_bf16 v[88:103], v[56:59], v[24:27], 0
    s_waitcnt lgkmcnt(10)
    v_mfma_f32_32x32x16_bf16 v[72:87], v[44:47], v[28:31], v[72:87]
    s_waitcnt lgkmcnt(8)
    v_mfma_f32_32x32x16_bf16 v[88:103], v[60:63], v[28:31], v[88:103]
    s_waitcnt lgkmcnt(6)
    v_mfma_f32_32x32x16_bf16 v[72:87], v[48:51], v[32:35], v[72:87]
    s_waitcnt lgkmcnt(4)
    v_mfma_f32_32x32x16_bf16 v[88:103], v[64:67], v[32:35], v[88:103]
    s_waitcnt lgkmcnt(2)
    v_mfma_f32_32x32x16_bf16 v[72:87], v[52:55], v[36:39], v[72:87]
    s_waitcnt lgkmcnt(0)
    v_mfma_f32_32x32x16_bf16 v[88:103], v[68:71], v[36:39], v[88:103]
    s_mov_b32 s40, 0xbfb8aa3b
    s_mov_b32 s41, 0x00800000
    s_mov_b32 s42, 0x7fff0000
    s_mov_b32 s43, 0x80000000
    s_nop 7
    s_nop 3
    s_mov_b32 s41, 0x41600000
    s_mov_b32 s42, 0x3affffff
    v_fma_f32 v72, s40, v72, -4.0
    v_fma_f32 v73, s40, v73, -4.0
    v_fma_f32 v74, s40, v74, -4.0
    v_fma_f32 v75, s40, v75, -4.0
    v_fma_f32 v76, s40, v76, -4.0
    v_fma_f32 v77, s40, v77, -4.0
    v_fma_f32 v78, s40, v78, -4.0
    v_fma_f32 v79, s40, v79, -4.0
    v_fma_f32 v80, s40, v80, -4.0
    v_fma_f32 v81, s40, v81, -4.0
    v_fma_f32 v82, s40, v82, -4.0
    v_fma_f32 v83, s40, v83, -4.0
    v_fma_f32 v84, s40, v84, -4.0
    v_fma_f32 v85, s40, v85, -4.0
    v_fma_f32 v86, s40, v86, -4.0
    v_fma_f32 v87, s40, v87, -4.0
    v_max_f32 v8, v72, v73
    v_max3_f32 v8, v8, v74, v75
    v_max3_f32 v8, v8, v76, v77
    v_max3_f32 v8, v8, v78, v79
    v_max3_f32 v8, v8, v80, v81
    v_max3_f32 v8, v8, v82, v83
    v_max3_f32 v8, v8, v84, v85
    v_max3_f32 v8, v8, v86, v87
    v_exp_f32 v72, v72
    v_exp_f32 v73, v73
    v_exp_f32 v74, v74
    v_exp_f32 v75, v75
    v_max_f32 v9, |v88|, |v89|
    v_max3_f32 v9, v9, |v90|, |v91|
    v_cvt_pk_f16_f32 v72, v72, v73
    v_cvt_pk_f16_f32 v73, v74, v75
    v_cvt_pk_f16_f32 v74, v88, v89
    v_cvt_pk_f16_f32 v75, v90, v91
    ds_write_b128 v104, v[72:75] offset:0
    v_exp_f32 v76, v76
    v_exp_f32 v77, v77
    v_exp_f32 v78, v78
    v_exp_f32 v79, v79
    v_max3_f32 v9, v9, |v92|, |v93|
    v_max3_f32 v9, v9, |v94|, |v95|
    v_cvt_pk_f16_f32 v76, v76, v77
    v_cvt_pk_f16_f32 v77, v78, v79
    v_cvt_pk_f16_f32 v78, v92, v93
    v_cvt_pk_f16_f32 v79, v94, v95
    ds_write_b128 v104, v[76:79] offset:16
    v_exp_f32 v80, v80
    v_exp_f32 v81, v81
    v_exp_f32 v82, v82
    v_exp_f32 v83, v83
    v_max3_f32 v9, v9, |v96|, |v97|
    v_max3_f32 v9, v9, |v98|, |v99|
    v_cvt_pk_f16_f32 v80, v80, v81
    v_cvt_pk_f16_f32 v81, v82, v83
    v_cvt_pk_f16_f32 v82, v96, v97
    v_cvt_pk_f16_f32 v83, v98, v99
    ds_write_b128 v104, v[80:83] offset:32
    v_exp_f32 v84, v84
    v_exp_f32 v85, v85
    v_exp_f32 v86, v86
    v_exp_f32 v87, v87
    v_max3_f32 v9, v9, |v100|, |v101|
    v_max3_f32 v9, v9, |v102|, |v103|
    v_cmp_ge_f32 vcc, s41, v8
    v_add_u32 v9, -1, v9
    v_cmp_le_u32 s[44:45], s42, v9
    v_cvt_pk_f16_f32 v84, v84, v85
    v_cvt_pk_f16_f32 v85, v86, v87
    v_cvt_pk_f16_f32 v86, v100, v101
    v_cvt_pk_f16_f32 v87, v102, v103
    s_and_b64 vcc, vcc, s[44:45]
    v_cndmask_b32 v84, -1, v84, vcc
    ds_write_b128 v104, v[84:87] offset:48
    s_waitcnt lgkmcnt(0)
    ds_read_b128 v[8:11], v105 offset:0
    ds_read_b128 v[12:15], v105 offset:1152
    ds_read_b128 v[16:19], v105 offset:2304
    ds_read_b128 v[20:23], v105 offset:3456
    s_waitcnt lgkmcnt(3)
    buffer_store_dwordx4 v[8:11], v2, s[52:55], 0 offen offset:0 sc1
    s_waitcnt lgkmcnt(2)
    buffer_store_dwordx4 v[12:15], v2, s[52:55], 0 offen offset:2048 sc1
    v_add_u32 v2, 4096, v2
    s_waitcnt lgkmcnt(1)
    buffer_store_dwordx4 v[16:19], v2, s[52:55], 0 offen offset:0 sc1
    s_waitcnt lgkmcnt(0)
    buffer_store_dwordx4 v[20:23], v2, s[52:55], 0 offen offset:2048 sc1
    s_endpgm
K1_FRAG:
    s_cmp_ge_u32 s7, 8
    s_cbranch_scc1 K1_END
    v_and_b32 v1, 63, v0
    v_lshrrev_b32 v4, 5, v1
    v_and_b32 v5, 15, v1
    v_lshrrev_b32 v6, 4, v1
    v_lshlrev_b32 v6, 1, v6
    v_lshl_add_u32 v5, v5, 3, v6
    s_waitcnt lgkmcnt(0)
    s_mov_b32 s36, s28
    s_and_b32 s37, s29, 0xffff
    s_mov_b32 s38, 0x4080
    s_mov_b32 s39, 0x20000
    buffer_load_dwordx4 v[8:11], v3, s[36:39], 0 offen
    s_mov_b32 s40, s24
    s_and_b32 s41, s25, 0xffff
    s_mov_b32 s42, 0x2000
    s_mov_b32 s43, 0x20000
    buffer_load_dwordx4 v[12:15], v3, s[40:43], 0 offen
    s_movk_i32 s4, 0x4000
    buffer_load_ushort v20, v5, s[36:39], s4 offen
    s_add_u32 s52, s32, 0x1100000
    s_addc_u32 s53, s33, 0
    s_and_b32 s53, s53, 0xffff
    s_mov_b32 s54, 0x4600
    s_mov_b32 s55, 0x20000
    v_bfe_u32 v6, v1, 2, 2
    v_lshl_add_u32 v6, v4, 3, v6
    v_lshlrev_b32 v6, 7, v6
    v_and_b32 v7, 1, v1
    v_lshl_add_u32 v6, v7, 5, v6
    v_bfe_u32 v7, v1, 4, 1
    v_lshl_add_u32 v6, v7, 4, v6
    v_bfe_u32 v7, v1, 1, 1
    v_lshl_add_u32 v6, v7, 3, v6
    s_lshr_b32 s4, s7, 1
    s_and_b32 s5, s7, 1
    s_lshl_b32 s4, s4, 13
    s_lshl_b32 s5, s5, 6
    s_add_u32 s4, s4, s5
    v_add_u32 v6, s4, v6
    v_lshlrev_b32 v2, 4, v1
    s_waitcnt vmcnt(2)
    ds_write_b128 v3, v[8:11] offset:0
    s_waitcnt vmcnt(1)
    ds_write_b128 v3, v[12:15] offset:8192
    s_waitcnt lgkmcnt(0)
    s_barrier
    s_cmp_eq_u32 s7, 4
    s_cbranch_scc1 K1_COEF
    s_cmp_gt_u32 s7, 4
    s_cbranch_scc1 K1_END
    ds_read_b64_tr_b16 v[40:41], v6 offset:0
    ds_read_b64_tr_b16 v[42:43], v6 offset:512
    ds_read_b64_tr_b16 v[44:45], v6 offset:2048
    ds_read_b64_tr_b16 v[46:47], v6 offset:2560
    ds_read_b64_tr_b16 v[48:49], v6 offset:4096
    ds_read_b64_tr_b16 v[50:51], v6 offset:4608
    ds_read_b64_tr_b16 v[52:53], v6 offset:6144
    ds_read_b64_tr_b16 v[54:55], v6 offset:6656
    s_lshl_b32 s4, s7, 12
    s_waitcnt lgkmcnt(6)
    buffer_store_dwordx4 v[40:43], v2, s[52:55], s4 offen offset:0 sc1
    s_waitcnt lgkmcnt(4)
    buffer_store_dwordx4 v[44:47], v2, s[52:55], s4 offen offset:1024 sc1
    s_waitcnt lgkmcnt(2)
    buffer_store_dwordx4 v[48:51], v2, s[52:55], s4 offen offset:2048 sc1
    s_waitcnt lgkmcnt(0)
    buffer_store_dwordx4 v[52:55], v2, s[52:55], s4 offen offset:3072 sc1
    s_endpgm
K1_COEF:
    s_waitcnt vmcnt(0)
    v_lshlrev_b32 v20, 16, v20
    v_and_b32 v60, 0x7fffffff, v20
    s_nop 1
    v_max_u32_dpp v60, v60, v60 row_shr:1 row_mask:0xf bank_mask:0xf
    s_nop 1
    v_max_u32_dpp v60, v60, v60 row_shr:2 row_mask:0xf bank_mask:0xf
    s_nop 1
    v_max_u32_dpp v60, v60, v60 row_shr:4 row_mask:0xf bank_mask:0xf
    s_nop 1
    v_max_u32_dpp v60, v60, v60 row_shr:8 row_mask:0xf bank_mask:0xf
    s_nop 1
    v_max_u32_dpp v60, v60, v60 row_bcast:15 row_mask:0xa bank_mask:0xf
    s_nop 1
    v_max_u32_dpp v60, v60, v60 row_bcast:31 row_mask:0xc bank_mask:0xf
    s_nop 1
    v_readlane_b32 s5, v60, 63
    s_lshr_b32 s4, s5, 23
    s_max_u32 s4, s4, 1
    s_lshl_b32 s8, s4, 23
    s_cmp_gt_u32 s4, 253
    s_cselect_b32 s8, 0x7fc00000, s8
    s_min_u32 s4, s4, 253
    s_sub_u32 s4, 254, s4
    s_lshl_b32 s4, s4, 23
    s_or_b32 s4, s4, 0x80000000
    v_mov_b32 v70, s5
    v_mul_f32 v60, s4, v20
    v_mul_f32 v70, s4, v70
    v_mul_f32 v70, v70, v70
    v_max_f32 v70, 1.0, v70
    v_rcp_f32 v71, v70
    v_mov_b32 v70, s8
    v_mul_f32 v61, v60, v60
    v_mul_f32 v62, v61, v60
    v_mul_f32 v63, v62, v60
    v_mul_f32 v64, v63, v60
    v_mul_f32 v65, v64, v60
    v_mul_f32 v66, v65, v60
    v_mul_f32 v67, v66, v60
    v_mul_f32 v61, 0x3f00ca86, v61
    v_mul_f32 v62, 0x3e32000a, v62
    v_mul_f32 v63, 0x3d1f848e, v63
    v_mul_f32 v64, 0x0, v64
    v_mul_f32 v65, 0x0, v65
    v_mul_f32 v66, 0x0, v66
    v_mul_f32 v67, 0x0, v67
    v_cvt_f16_f32 v60, v60
    v_cvt_f16_f32 v61, v61
    v_cvt_f16_f32 v62, v62
    v_cvt_f16_f32 v63, v63
    v_cvt_f16_f32 v64, v64
    v_cvt_f16_f32 v65, v65
    v_cvt_f16_f32 v66, v66
    v_cvt_f16_f32 v67, v67
    v_pack_b32_f16 v40, v60, v61
    v_pack_b32_f16 v41, v62, v63
    v_pack_b32_f16 v42, v64, v65
    v_pack_b32_f16 v43, v66, v67
    s_movk_i32 s4, 16384
    buffer_store_dwordx4 v[40:43], v2, s[52:55], s4 offen sc1
    v_lshlrev_b32 v2, 3, v1
    buffer_store_dwordx2 v[70:71], v2, s[52:55], s4 offen offset:1024 sc1
K1_END:
    s_endpgm
.globl k2_kernel
.p2align 8
.type k2_kernel,@function
k2_kernel:
    s_cmp_ge_u32 s2, 256
    s_cbranch_scc1 K2_END
    s_load_dwordx16 s[16:31], s[0:1], 0
    s_load_dwordx2 s[32:33], s[0:1], 72
    s_and_b32 s3, s2, 7
    s_lshr_b32 s2, s2, 3
    s_lshl_b32 s3, s3, 5
    s_or_b32 s2, s2, s3
    v_lshrrev_b32 v22, 6, v0
    v_and_b32 v1, 63, v0
    v_readfirstlane_b32 s7, v22
    v_mul_u32_u24 v8, 10923, v0
    v_lshrrev_b32 v8, 16, v8
    v_lshlrev_b32 v19, 6, v8
    v_cmp_gt_u32 vcc, 160, v8
    s_lshr_b32 s3, s2, 4
    s_lshl_b32 s3, s3, 14
    s_and_b32 s4, s2, 15
    s_lshl2_add_u32 s57, s4, s3
    s_add_u32 s57, s57, 0x800000
    v_cndmask_b32 v19, 0.5, v19, vcc
    v_and_b32 v22, 15, v0
    v_lshlrev_b32 v2, 4, v22
    v_lshlrev_b32 v22, 4, v1
    v_lshlrev_b32 v21, 3, v1
    s_lshr_b32 s9, s7, 1
    s_lshl_b32 s5, s9, 12
    s_add_u32 s5, s5, 0x8fc000
    s_mov_b32 s10, 0x904000
    s_mul_i32 s8, s2, 6272
    s_lshl_b32 s9, s7, 10
    s_add_u32 s8, s8, s9
    s_cmp_ge_u32 s7, 12
    s_cselect_b32 s8, 0.5, s8
    v_mul_u32_u24 v7, 516, v1
    v_add_u32 v7, 117056, v7
    v_cmp_gt_u32 vcc, 64, v0
    v_and_b32 v23, 511, v0
    v_lshlrev_b32 v23, 2, v23
    v_cndmask_b32 v48, 0, v7, vcc
    v_cmp_gt_u32 vcc, 512, v0
    v_mov_b32 v56, 0x7b00
    v_mov_b32 v57, 0x7b00
    v_mov_b32 v58, 0x7b00
    v_mov_b32 v59, 0x7b00
    v_lshlrev_b32 v49, 4, v0
    v_mov_b64 v[60:61], 0
    v_mov_b64 v[62:63], 0
    ds_write_b128 v49, v[60:63] offset:0
    v_add_u32 v50, 72320, v49
    ds_write_b128 v50, v[60:63]
    v_add_u32 v49, 117056, v49
    s_mov_b64 exec, vcc
    ds_write_b32 v23, v48 offset:28480
    s_mov_b64 exec, -1
    v_cmp_gt_u32 vcc, 576, v0
    ds_write_b128 v49, v[56:59]
    s_mov_b64 exec, vcc
    ds_write_b128 v49, v[56:59] offset:16384
    s_mov_b64 exec, -1
    s_mov_b32 s42, 0x1000000
    s_mov_b32 s43, 0x20000
    s_mov_b32 s38, 0x30d4
    s_mov_b32 s39, 0x20000
    s_mov_b32 s54, 0x186a00
    s_mov_b32 s55, 0x20000
    s_mov_b32 s58, 0
    s_and_b32 s48, s2, 31
    s_mul_i32 s48, s48, 391
    s_mov_b32 s11, 142648
    s_mov_b32 s14, 0x1104400
    v_lshrrev_b32 v125, 1, v1
    v_and_b32 v127, 1, v0
    v_lshlrev_b32 v127, 7, v127
    v_lshrrev_b32 v3, 4, v0
    v_mul_u32_u24 v3, 272, v3
    v_add_u32 v3, v3, v2
    v_mul_u32_u24 v23, 6, v8
    v_sub_u32 v23, v0, v23
    v_mul_u32_u24 v6, 3, v23
    v_mul_u32_u24 v20, 1840, v8
    v_add_u32 v20, v20, v23
    v_mov_b32 v4, 4
    v_mov_b32 v51, 0.5
    s_waitcnt lgkmcnt(0)
    s_add_u32 s40, s32, 0x800000
    s_addc_u32 s41, s33, 0
    s_and_b32 s41, s41, 0xffff
    buffer_load_dword v9, v19, s[40:43], s57 offen
    s_load_dwordx2 s[100:101], s[32:33], s14
    s_barrier
    s_mov_b32 s52, s16
    s_and_b32 s53, s17, 0xffff
    s_mov_b32 s36, s32
    s_and_b32 s37, s33, 0xffff
    s_or_b32 s37, s37, 0x1000000
    s_lshr_b32 s3, s7, 2
    s_cmp_eq_u32 s3, 2
    s_cbranch_scc1 K2_GEMM
    v_lshrrev_b32 v56, 3, v0
    v_mul_u32_u24 v56, 144, v56
    v_and_b32 v57, 7, v0
    v_lshl_add_u32 v56, v57, 4, v56
    v_add_u32 v56, 48960, v56
    s_cmp_lg_u32 s7, 7
    s_cbranch_scc1 K2_NW7
    s_mov_b32 s52, s40
    s_mov_b32 s53, s41
    s_mov_b32 s54, s42
    s_mov_b32 s55, s43
    s_mov_b32 s8, s10
    v_add_u32 v56, 30528, v22
K2_NW7:
    buffer_load_dwordx4 v[52:55], v22, s[52:55], s8 offen
    s_waitcnt vmcnt(1)
    v_and_b32 v23, 0xffff, v9
    v_lshrrev_b32 v5, 16, v9
    v_sub_u32 v23, v23, v6 clamp
    v_add_lshl_u32 v5, v5, v20, 4
    v_cmp_lt_u32 s[60:61], 0, v23
    v_cmp_lt_u32 s[66:67], 18, v23
    v_cmp_lt_u32 s[72:73], 36, v23
    v_cndmask_b32 v48, v51, v5, s[60:61]
    buffer_load_dwordx4 v[24:27], v48, s[40:43], 0 offen offset:0
    v_cndmask_b32 v49, v51, v5, s[66:67]
    buffer_load_dwordx4 v[28:31], v49, s[40:43], 0 offen offset:96
    s_cmp_eq_u64 s[72:73], 0
    s_cbranch_scc1 K2_NOL2X
    v_cndmask_b32 v50, v51, v5, s[72:73]
    buffer_load_dwordx4 v[32:35], v50, s[40:43], 0 offen offset:192
K2_NOL2X:
    v_cmp_lt_u32 s[62:63], 1, v23
    v_cmp_lt_u32 s[64:65], 2, v23
    v_cmp_lt_u32 s[68:69], 19, v23
    v_cmp_lt_u32 s[70:71], 20, v23
    v_cmp_lt_u32 s[74:75], 37, v23
    v_cmp_lt_u32 s[76:77], 38, v23
    s_waitcnt vmcnt(2)
    ds_write_b128 v56, v[52:55] offset:0
    s_waitcnt lgkmcnt(0)
    s_barrier
K2_RANK:
    s_waitcnt vmcnt(1)
    v_and_b32 v36, 0xff, v27
    v_bfe_u32 v37, v27, 8, 8
    v_bfe_u32 v38, v27, 16, 8
    s_mov_b64 exec, s[60:61]
    ds_add_rtn_u32 v36, v36, v4 offset:28480
    s_mov_b64 exec, s[62:63]
    ds_add_rtn_u32 v37, v37, v4 offset:28480
    s_mov_b64 exec, s[64:65]
    ds_add_rtn_u32 v38, v38, v4 offset:28480
    s_mov_b64 exec, -1
    s_waitcnt vmcnt(0)
    v_and_b32 v39, 0xff, v31
    v_bfe_u32 v40, v31, 8, 8
    v_bfe_u32 v41, v31, 16, 8
    s_mov_b64 exec, s[66:67]
    ds_add_rtn_u32 v39, v39, v4 offset:28480
    s_mov_b64 exec, s[68:69]
    ds_add_rtn_u32 v40, v40, v4 offset:28480
    s_mov_b64 exec, s[70:71]
    ds_add_rtn_u32 v41, v41, v4 offset:28480
    s_mov_b64 exec, -1
    s_mul_i32 s4, s7, 9
    s_add_u32 s3, s48, s4
    v_cmp_gt_u32 vcc, 18, v1
    v_add_u32 v126, s3, v125
    s_nop 0
    v_cndmask_b32 v126, -1, v126, vcc
    buffer_load_dword v120, v[126:127], s[36:39], 0 idxen offen
    s_waitcnt lgkmcnt(5)
    s_mov_b64 exec, s[60:61]
    v_min_u32 v36, s11, v36
    ds_write_b32 v36, v24
    s_waitcnt lgkmcnt(5)
    s_mov_b64 exec, s[62:63]
    v_min_u32 v37, s11, v37
    ds_write_b32 v37, v25
    s_waitcnt lgkmcnt(5)
    s_mov_b64 exec, s[64:65]
    v_min_u32 v38, s11, v38
    ds_write_b32 v38, v26
    s_waitcnt lgkmcnt(5)
    s_mov_b64 exec, s[66:67]
    v_min_u32 v39, s11, v39
    ds_write_b32 v39, v28
    s_waitcnt lgkmcnt(5)
    s_mov_b64 exec, s[68:69]
    v_min_u32 v40, s11, v40
    ds_write_b32 v40, v29
    s_waitcnt lgkmcnt(5)
    s_mov_b64 exec, s[70:71]
    v_min_u32 v41, s11, v41
    ds_write_b32 v41, v30
    s_mov_b64 exec, -1
    s_cmp_eq_u64 s[72:73], 0
    s_cbranch_scc0 K2_R3X
K2_NOR3X:
    s_cmp_gt_u32 s7, 3
    s_cselect_b32 s69, 0, 1
    s_cbranch_scc1 K2_JOIN
    s_add_u32 s5, s5, 24576
    buffer_load_dwordx4 v[84:87], v22, s[40:43], s5 offen offset:0
    buffer_load_dwordx4 v[92:95], v22, s[40:43], s5 offen offset:1024
    buffer_load_dwordx4 v[96:99], v22, s[40:43], s5 offen offset:2048
    buffer_load_dwordx4 v[120:123], v22, s[40:43], s5 offen offset:3072
K2_JOIN:
    v_lshlrev_b32 v52, 2, v1
    s_waitcnt lgkmcnt(0)
    s_barrier
    ds_read_b32 v53, v52 offset:28480
    ds_read_b128 v[10:13], v22 offset:30528
    s_waitcnt lgkmcnt(1)
    v_sub_u32 v53, v53, v7
    v_add_u32 v56, 12, v53
    v_lshrrev_b32 v56, 4, v56
    v_mov_b32 v18, v56
    s_nop 1
    v_add_u32_dpp v18, v18, v18 row_shr:1 row_mask:0xf bank_mask:0xf
    s_nop 1
    v_add_u32_dpp v18, v18, v18 row_shr:2 row_mask:0xf bank_mask:0xf
    s_nop 1
    v_add_u32_dpp v18, v18, v18 row_shr:4 row_mask:0xf bank_mask:0xf
    s_nop 1
    v_add_u32_dpp v18, v18, v18 row_shr:8 row_mask:0xf bank_mask:0xf
    s_nop 1
    v_add_u32_dpp v18, v18, v18 row_bcast:15 row_mask:0xa bank_mask:0xf
    s_nop 1
    v_add_u32_dpp v18, v18, v18 row_bcast:31 row_mask:0xc bank_mask:0xf
    v_cmp_lt_u32 vcc, 32, v56
    v_cmp_ne_u32 s[60:61], 0, v56
    v_readlane_b32 s12, v18, 63
    v_sub_u32 v19, v18, v56
    v_lshlrev_b32 v57, 4, v19
    v_sub_u32 v20, v7, v57
    s_cbranch_vccnz K2_GENERAL
    s_cmp_gt_u32 s12, 1024
    s_cbranch_scc1 K2_GENERAL
K2_SETUP:
    s_mul_i32 s13, s12, s7
    s_add_u32 s14, s13, s12
    s_lshr_b32 s74, s13, 4
    s_lshr_b32 s75, s14, 4
    v_cmp_lt_u32 vcc, s74, v18
    s_mov_b32 s4, 0x7fffffff
    v_writelane_b32 v19, s4, 63
    s_mov_b32 s68, 0
    s_cmp_eq_u32 s74, s75
    s_cbranch_scc1 K2_NOWORK
    s_and_b64 s[60:61], s[60:61], vcc
    s_ff1_i32_b64 s81, s[60:61]
    s_bitset0_b64 s[60:61], s81
    s_mov_b64 s[62:63], s[60:61]
    s_bitset1_b64 s[62:63], 63
    s_ff1_i32_b64 s66, s[62:63]
    v_readlane_b32 s65, v20, s81
    v_readlane_b32 s67, v19, s66
    v_lshrrev_b32 v116, 4, v1
    v_and_b32 v115, 3, v1
    v_lshl_or_b32 v116, v116, 2, v115
    v_and_b32 v115, 12, v1
    s_lshl_b32 s4, s74, 4
    v_lshl_or_b32 v115, v116, 4, v115
    v_add_u32 v115, s4, v115
    s_mov_b32 s64, s74
    v_add_u32 v117, s65, v115
    s_sub_u32 s4, s67, s64
    s_cmp_ge_u32 s4, 16
    s_cbranch_scc1 K2_MD0
K2_ML0:
    v_readlane_b32 s65, v20, s66
    s_bitset0_b64 s[62:63], s66
    s_ff1_i32_b64 s66, s[62:63]
    v_readlane_b32 s67, v19, s66
    v_cmpx_le_u32 vcc, s4, v116
    v_add_u32 v117, s65, v115
    s_mov_b64 exec, -1
    s_sub_u32 s4, s67, s64
    s_cmp_lt_u32 s4, 16
    s_cbranch_scc1 K2_ML0
K2_MD0:
    ds_read_b32 v114, v117
    s_add_u32 s64, s64, 16
    v_lshrrev_b32 v112, 4, v1
    v_lshlrev_b32 v112, 2, v112
    s_lshl_b32 s4, s74, 4
    s_add_u32 s4, s4, 31552
    v_add_u32 v109, s4, v112
    v_mov_b32 v25, v2
    v_mov_b32 v27, v2
    v_mov_b32 v29, v2
    v_mov_b32 v31, v2
    v_readlane_b32 s79, v18, s81
    v_readlane_b32 s5, v19, s81
    s_mul_i32 s4, s81, 272
    v_add_u32 v113, s4, v2
    v_add_u32 v124, v2, v112
    v_add_u32 v111, s4, v124
    ds_read_b32 v89, v111 offset:14336
    v_mov_b32 v125, v111
    s_cmp_lt_u32 s5, s74
    s_cbranch_scc0 K2_NOSHARE
    v_add_u32 v111, 72320, v111
    v_mov_b32 v125, 29504
    s_sub_u32 s4, s13, s12
    s_lshr_b32 s4, s4, 4
    s_cmp_lt_u32 s5, s4
    s_cselect_b32 s68, 1, s58
    s_cmp_gt_u32 s79, s75
    s_cselect_b32 s68, 1, s68
K2_NOSHARE:
    ds_read_b32 v88, v125
    ds_read_b128 v[72:75], v113 offset:14336
    s_min_u32 s78, s79, s75
    s_sub_u32 s78, s78, s74
    s_mov_b32 s76, s74
    s_mov_b32 s80, 0x7a800000
    s_waitcnt lgkmcnt(3)
    ds_write_b32 v115, v114 offset:31552
    ds_read_u16 v24, v109 offset:0
    ds_read_u16 v26, v109 offset:16
    ds_read_u16 v28, v109 offset:32
    ds_read_u16 v30, v109 offset:48
    v_and_b32 v105, 0xffff0000, v114
    v_mul_f32 v105, s100, v105
    v_mul_f32 v106, v105, v105
    v_cmp_ge_f32 vcc, s101, v106
    v_cvt_pkrtz_f16_f32 v104, v105, v106
    s_waitcnt lgkmcnt(3)
    buffer_load_dwordx4 v[64:67], v[24:25], s[36:39], 0 idxen offen
    s_waitcnt lgkmcnt(2)
    buffer_load_dwordx4 v[68:71], v[26:27], s[36:39], 0 idxen offen
    s_waitcnt lgkmcnt(1)
    buffer_load_dwordx4 v[14:17], v[28:29], s[36:39], 0 idxen offen
    ds_read_u16 v24, v109 offset:64
    ds_read_u16 v26, v109 offset:80
    v_add_u32 v115, 0x100, v115
    v_cndmask_b32 v76, -1, v104, vcc
    v_pk_mul_f16 v77, v76, v76 op_sel:[0,1] op_sel_hi:[1,1]
    v_mov_b64 v[80:81], 0
    s_nop 0
    v_mfma_f32_16x16x4_4b_f16 v[32:47], v[76:77], v[10:11], 1.0 cbsz:2 abid:0
    v_add_u32 v117, s65, v115
    s_sub_u32 s4, s67, s64
    s_cmp_ge_u32 s4, 16
    s_cbranch_scc1 K2_MD1
K2_ML1:
    v_readlane_b32 s65, v20, s66
    s_bitset0_b64 s[62:63], s66
    s_ff1_i32_b64 s66, s[62:63]
    v_readlane_b32 s67, v19, s66
    v_cmpx_le_u32 vcc, s4, v116
    v_add_u32 v117, s65, v115
    s_mov_b64 exec, -1
    s_sub_u32 s4, s67, s64
    s_cmp_lt_u32 s4, 16
    s_cbranch_scc1 K2_ML1
K2_MD1:
    ds_read_b32 v114, v117
    s_add_u32 s64, s64, 16
    s_waitcnt lgkmcnt(0)
    s_cmp_eq_u32 s69, 0
    s_cbranch_scc1 K2_NOXU
K2_XU:
    s_mov_b32 s69, 0
    s_and_b32 s3, s7, 1
    s_lshl_b32 s3, s3, 5
    v_and_b32 v118, 31, v1
    v_lshrrev_b32 v119, 5, v1
    v_add_u32 v118, s3, v118
    v_mul_u32_u24 v126, 144, v118
    v_lshl_add_u32 v126, v119, 4, v126
    ds_read_b128 v[4:7], v126 offset:48960
    ds_read_b128 v[100:103], v126 offset:48992
    ds_read_b128 v[104:107], v126 offset:49024
    v_cmp_gt_u32 s[70:71], 49, v118
    v_mul_u32_u24 v118, 272, v118
    v_lshl_add_u32 v118, v119, 6, v118
    s_bfe_u32 s3, s7, 0x10001
    s_lshl_b32 s3, s3, 7
    v_add_u32 v118, s3, v118
    s_waitcnt vmcnt(3)
    s_waitcnt lgkmcnt(2)
    v_mfma_f32_32x32x16_bf16 v[48:63], v[84:87], v[4:7], 0
    ds_read_b128 v[4:7], v126 offset:49056
    s_waitcnt lgkmcnt(2)
    v_mfma_f32_32x32x16_bf16 v[48:63], v[92:95], v[100:103], v[48:63]
    s_waitcnt lgkmcnt(1)
    v_mfma_f32_32x32x16_bf16 v[48:63], v[96:99], v[104:107], v[48:63]
    s_waitcnt lgkmcnt(0)
    v_mfma_f32_32x32x16_bf16 v[48:63], v[120:123], v[4:7], v[48:63]
    s_nop 7
    s_nop 4
    s_mov_b64 exec, s[70:71]
    ds_write_b128 v118, v[48:51] offset:58176
    ds_write_b128 v118, v[52:55] offset:58192
    ds_write_b128 v118, v[56:59] offset:58208
    ds_write_b128 v118, v[60:63] offset:58224
    s_mov_b64 exec, -1
    s_waitcnt lgkmcnt(0)
    s_cmp_eq_u32 s74, s75
    s_cbranch_scc1 K2_MAINDONE
K2_NOXU:
    s_setprio 3
K2_LOOP:
    ds_read_u16 v28, v109 offset:96
    s_waitcnt lgkmcnt(3)
    buffer_load_dwordx4 v[4:7], v[30:31], s[36:39], 0 idxen offen
    v_mfma_f32_16x16x4_4b_f16 v[48:63], v[76:77], v[10:11], 1.0 cbsz:2 abid:1
    v_cvt_pk_f16_f32 v94, v32, v36
    v_cvt_pk_f16_f32 v95, v40, v44
    s_waitcnt vmcnt(3)
    v_pk_fma_f16 v92, v64, v94, v72
    v_pk_fma_f16 v93, v65, v95, v74
    v_rcp_f16 v84, v92
    v_rcp_f16 v85, v93
    v_rcp_f16_sdwa v84, v92 dst_sel:WORD_1 dst_unused:UNUSED_PRESERVE src0_sel:WORD_1
    v_rcp_f16_sdwa v85, v93 dst_sel:WORD_1 dst_unused:UNUSED_PRESERVE src0_sel:WORD_1
    v_pk_fma_f16 v80, v66, v84, v80
    v_pk_fma_f16 v81, v67, v85, v81
    s_cmp_eq_u32 s78, 1
    s_cbranch_scc1 K2_FL0
K2_BK0:
    ds_read_u16 v30, v109 offset:112
    s_waitcnt lgkmcnt(3)
    buffer_load_dwordx4 v[64:67], v[24:25], s[36:39], 0 idxen offen
    v_cvt_pk_f16_f32 v94, v33, v37
    v_cvt_pk_f16_f32 v95, v41, v45
    s_waitcnt vmcnt(3)
    v_pk_fma_f16 v92, v68, v94, v72
    v_pk_fma_f16 v93, v69, v95, v74
    v_rcp_f16 v84, v92
    v_rcp_f16 v85, v93
    v_rcp_f16_sdwa v84, v92 dst_sel:WORD_1 dst_unused:UNUSED_PRESERVE src0_sel:WORD_1
    v_rcp_f16_sdwa v85, v93 dst_sel:WORD_1 dst_unused:UNUSED_PRESERVE src0_sel:WORD_1
    v_pk_fma_f16 v80, v70, v84, v80
    v_pk_fma_f16 v81, v71, v85, v81
    s_cmp_eq_u32 s78, 2
    s_cbranch_scc1 K2_FL1
K2_BK1:
    ds_read_u16 v24, v109 offset:128
    s_waitcnt lgkmcnt(3)
    buffer_load_dwordx4 v[68:71], v[26:27], s[36:39], 0 idxen offen
    v_cvt_pk_f16_f32 v94, v34, v38
    v_cvt_pk_f16_f32 v95, v42, v46
    s_waitcnt vmcnt(3)
    v_pk_fma_f16 v92, v14, v94, v72
    v_pk_fma_f16 v93, v15, v95, v74
    v_rcp_f16 v84, v92
    v_rcp_f16 v85, v93
    v_rcp_f16_sdwa v84, v92 dst_sel:WORD_1 dst_unused:UNUSED_PRESERVE src0_sel:WORD_1
    v_rcp_f16_sdwa v85, v93 dst_sel:WORD_1 dst_unused:UNUSED_PRESERVE src0_sel:WORD_1
    v_pk_fma_f16 v80, v16, v84, v80
    v_pk_fma_f16 v81, v17, v85, v81
    s_cmp_eq_u32 s78, 3
    s_cbranch_scc1 K2_FL2
K2_BK2:
    ds_read_u16 v26, v109 offset:144
    s_waitcnt lgkmcnt(3)
    buffer_load_dwordx4 v[14:17], v[28:29], s[36:39], 0 idxen offen
    v_cvt_pk_f16_f32 v94, v35, v39
    v_cvt_pk_f16_f32 v95, v43, v47
    s_waitcnt vmcnt(3)
    v_pk_fma_f16 v92, v4, v94, v72
    v_pk_fma_f16 v93, v5, v95, v74
    v_rcp_f16 v84, v92
    v_rcp_f16 v85, v93
    v_rcp_f16_sdwa v84, v92 dst_sel:WORD_1 dst_unused:UNUSED_PRESERVE src0_sel:WORD_1
    v_rcp_f16_sdwa v85, v93 dst_sel:WORD_1 dst_unused:UNUSED_PRESERVE src0_sel:WORD_1
    v_pk_fma_f16 v80, v6, v84, v80
    v_pk_fma_f16 v81, v7, v85, v81
    s_cmp_eq_u32 s78, 4
    s_cbranch_scc1 K2_FL3
K2_BK3:
    ds_read_u16 v28, v109 offset:160
    s_waitcnt lgkmcnt(3)
    buffer_load_dwordx4 v[4:7], v[30:31], s[36:39], 0 idxen offen
    v_mfma_f32_16x16x4_4b_f16 v[32:47], v[76:77], v[10:11], 1.0 cbsz:2 abid:2
    v_cvt_pk_f16_f32 v94, v48, v52
    v_cvt_pk_f16_f32 v95, v56, v60
    s_waitcnt vmcnt(3)
    v_pk_fma_f16 v92, v64, v94, v72
    v_pk_fma_f16 v93, v65, v95, v74
    v_rcp_f16 v84, v92
    v_rcp_f16 v85, v93
    v_rcp_f16_sdwa v84, v92 dst_sel:WORD_1 dst_unused:UNUSED_PRESERVE src0_sel:WORD_1
    v_rcp_f16_sdwa v85, v93 dst_sel:WORD_1 dst_unused:UNUSED_PRESERVE src0_sel:WORD_1
    v_pk_fma_f16 v80, v66, v84, v80
    v_pk_fma_f16 v81, v67, v85, v81
    s_cmp_eq_u32 s78, 5
    s_cbranch_scc1 K2_FL4
K2_BK4:
    ds_read_u16 v30, v109 offset:176
    s_waitcnt lgkmcnt(3)
    buffer_load_dwordx4 v[64:67], v[24:25], s[36:39], 0 idxen offen
    v_cvt_pk_f16_f32 v94, v49, v53
    v_cvt_pk_f16_f32 v95, v57, v61
    s_waitcnt vmcnt(3)
    v_pk_fma_f16 v92, v68, v94, v72
    v_pk_fma_f16 v93, v69, v95, v74
    v_rcp_f16 v84, v92
    v_rcp_f16 v85, v93
    v_rcp_f16_sdwa v84, v92 dst_sel:WORD_1 dst_unused:UNUSED_PRESERVE src0_sel:WORD_1
    v_rcp_f16_sdwa v85, v93 dst_sel:WORD_1 dst_unused:UNUSED_PRESERVE src0_sel:WORD_1
    v_pk_fma_f16 v80, v70, v84, v80
    v_pk_fma_f16 v81, v71, v85, v81
    s_cmp_eq_u32 s78, 6
    s_cbranch_scc1 K2_FL5
K2_BK5:
    ds_read_u16 v24, v109 offset:192
    s_waitcnt lgkmcnt(3)
    buffer_load_dwordx4 v[68:71], v[26:27], s[36:39], 0 idxen offen
    v_cvt_pk_f16_f32 v94, v50, v54
    v_cvt_pk_f16_f32 v95, v58, v62
    s_waitcnt vmcnt(3)
    v_pk_fma_f16 v92, v14, v94, v72
    v_pk_fma_f16 v93, v15, v95, v74
    v_rcp_f16 v84, v92
    v_rcp_f16 v85, v93
    v_rcp_f16_sdwa v84, v92 dst_sel:WORD_1 dst_unused:UNUSED_PRESERVE src0_sel:WORD_1
    v_rcp_f16_sdwa v85, v93 dst_sel:WORD_1 dst_unused:UNUSED_PRESERVE src0_sel:WORD_1
    v_pk_fma_f16 v80, v16, v84, v80
    v_pk_fma_f16 v81, v17, v85, v81
    s_cmp_eq_u32 s78, 7
    s_cbranch_scc1 K2_FL6
K2_BK6:
    ds_read_u16 v26, v109 offset:208
    s_waitcnt lgkmcnt(3)
    buffer_load_dwordx4 v[14:17], v[28:29], s[36:39], 0 idxen offen
    v_cvt_pk_f16_f32 v94, v51, v55
    v_cvt_pk_f16_f32 v95, v59, v63
    s_waitcnt vmcnt(3)
    v_pk_fma_f16 v92, v4, v94, v72
    v_pk_fma_f16 v93, v5, v95, v74
    v_rcp_f16 v84, v92
    v_rcp_f16 v85, v93
    v_rcp_f16_sdwa v84, v92 dst_sel:WORD_1 dst_unused:UNUSED_PRESERVE src0_sel:WORD_1
    v_rcp_f16_sdwa v85, v93 dst_sel:WORD_1 dst_unused:UNUSED_PRESERVE src0_sel:WORD_1
    v_pk_fma_f16 v80, v6, v84, v80
    v_pk_fma_f16 v81, v7, v85, v81
    s_cmp_eq_u32 s78, 8
    s_cbranch_scc1 K2_FL7
K2_BK7:
    s_sub_u32 s3, s75, s74
    s_cmp_gt_i32 s3, 32
    s_cbranch_scc1 K2_PRXM
    s_setprio 2
    s_cmp_gt_i32 s3, 24
    s_cbranch_scc1 K2_PRXM
    s_setprio 1
    s_cmp_gt_i32 s3, 16
    s_cbranch_scc1 K2_PRXM
    s_setprio 0
K2_PRXM:
    ds_read_u16 v28, v109 offset:224
    s_waitcnt lgkmcnt(3)
    buffer_load_dwordx4 v[4:7], v[30:31], s[36:39], 0 idxen offen
    v_mfma_f32_16x16x4_4b_f16 v[48:63], v[76:77], v[10:11], 1.0 cbsz:2 abid:3
    v_cvt_pk_f16_f32 v94, v32, v36
    v_cvt_pk_f16_f32 v95, v40, v44
    s_waitcnt vmcnt(3)
    v_pk_fma_f16 v92, v64, v94, v72
    v_pk_fma_f16 v93, v65, v95, v74
    v_rcp_f16 v84, v92
    v_rcp_f16 v85, v93
    v_rcp_f16_sdwa v84, v92 dst_sel:WORD_1 dst_unused:UNUSED_PRESERVE src0_sel:WORD_1
    v_rcp_f16_sdwa v85, v93 dst_sel:WORD_1 dst_unused:UNUSED_PRESERVE src0_sel:WORD_1
    v_pk_fma_f16 v80, v66, v84, v80
    v_pk_fma_f16 v81, v67, v85, v81
    s_cmp_eq_u32 s78, 9
    s_cbranch_scc1 K2_FL8
K2_BK8:
    ds_write_b32 v115, v114 offset:31552
    v_and_b32 v105, 0xffff0000, v114
    v_mul_f32 v105, s100, v105
    v_mul_f32 v106, v105, v105
    v_cmp_ge_f32 vcc, s101, v106
    v_cvt_pkrtz_f16_f32 v104, v105, v106
    v_add_u32 v115, 0x100, v115
    v_cndmask_b32 v76, -1, v104, vcc
    v_pk_mul_f16 v77, v76, v76 op_sel:[0,1] op_sel_hi:[1,1]
    v_add_u32 v117, s65, v115
    s_sub_u32 s4, s67, s64
    s_cmp_ge_u32 s4, 16
    s_cbranch_scc1 K2_MD2
K2_ML2:
    v_readlane_b32 s65, v20, s66
    s_bitset0_b64 s[62:63], s66
    s_ff1_i32_b64 s66, s[62:63]
    v_readlane_b32 s67, v19, s66
    v_cmpx_le_u32 vcc, s4, v116
    v_add_u32 v117, s65, v115
    s_mov_b64 exec, -1
    s_sub_u32 s4, s67, s64
    s_cmp_lt_u32 s4, 16
    s_cbranch_scc1 K2_ML2
K2_MD2:
    ds_read_b32 v114, v117
    s_add_u32 s64, s64, 16
    ds_read_u16 v30, v109 offset:240
    s_waitcnt lgkmcnt(3)
    buffer_load_dwordx4 v[64:67], v[24:25], s[36:39], 0 idxen offen
    v_cvt_pk_f16_f32 v94, v33, v37
    v_cvt_pk_f16_f32 v95, v41, v45
    s_waitcnt vmcnt(3)
    v_pk_fma_f16 v92, v68, v94, v72
    v_pk_fma_f16 v93, v69, v95, v74
    v_rcp_f16 v84, v92
    v_rcp_f16 v85, v93
    v_rcp_f16_sdwa v84, v92 dst_sel:WORD_1 dst_unused:UNUSED_PRESERVE src0_sel:WORD_1
    v_rcp_f16_sdwa v85, v93 dst_sel:WORD_1 dst_unused:UNUSED_PRESERVE src0_sel:WORD_1
    v_pk_fma_f16 v80, v70, v84, v80
    v_pk_fma_f16 v81, v71, v85, v81
    s_cmp_eq_u32 s78, 10
    s_cbranch_scc1 K2_FL9
K2_BK9:
    ds_read_u16 v24, v109 offset:256
    s_waitcnt lgkmcnt(3)
    buffer_load_dwordx4 v[68:71], v[26:27], s[36:39], 0 idxen offen
    v_cvt_pk_f16_f32 v94, v34, v38
    v_cvt_pk_f16_f32 v95, v42, v46
    s_waitcnt vmcnt(3)
    v_pk_fma_f16 v92, v14, v94, v72
    v_pk_fma_f16 v93, v15, v95, v74
    v_rcp_f16 v84, v92
    v_rcp_f16 v85, v93
    v_rcp_f16_sdwa v84, v92 dst_sel:WORD_1 dst_unused:UNUSED_PRESERVE src0_sel:WORD_1
    v_rcp_f16_sdwa v85, v93 dst_sel:WORD_1 dst_unused:UNUSED_PRESERVE src0_sel:WORD_1
    v_pk_fma_f16 v80, v16, v84, v80
    v_pk_fma_f16 v81, v17, v85, v81
    s_cmp_eq_u32 s78, 11
    s_cbranch_scc1 K2_FL10
K2_BK10:
    ds_read_u16 v26, v109 offset:272
    s_waitcnt lgkmcnt(3)
    buffer_load_dwordx4 v[14:17], v[28:29], s[36:39], 0 idxen offen
    v_cvt_pk_f16_f32 v94, v35, v39
    v_cvt_pk_f16_f32 v95, v43, v47
    s_waitcnt vmcnt(3)
    v_pk_fma_f16 v92, v4, v94, v72
    v_pk_fma_f16 v93, v5, v95, v74
    v_rcp_f16 v84, v92
    v_rcp_f16 v85, v93
    v_rcp_f16_sdwa v84, v92 dst_sel:WORD_1 dst_unused:UNUSED_PRESERVE src0_sel:WORD_1
    v_rcp_f16_sdwa v85, v93 dst_sel:WORD_1 dst_unused:UNUSED_PRESERVE src0_sel:WORD_1
    v_pk_fma_f16 v80, v6, v84, v80
    v_pk_fma_f16 v81, v7, v85, v81
    s_cmp_eq_u32 s78, 12
    s_cbranch_scc1 K2_FL11
K2_BK11:
    ds_read_u16 v28, v109 offset:288
    s_waitcnt lgkmcnt(3)
    buffer_load_dwordx4 v[4:7], v[30:31], s[36:39], 0 idxen offen
    v_mfma_f32_16x16x4_4b_f16 v[32:47], v[76:77], v[10:11], 1.0 cbsz:2 abid:0
    v_cvt_pk_f16_f32 v94, v48, v52
    v_cvt_pk_f16_f32 v95, v56, v60
    s_waitcnt vmcnt(3)
    v_pk_fma_f16 v92, v64, v94, v72
    v_pk_fma_f16 v93, v65, v95, v74
    v_rcp_f16 v84, v92
    v_rcp_f16 v85, v93
    v_rcp_f16_sdwa v84, v92 dst_sel:WORD_1 dst_unused:UNUSED_PRESERVE src0_sel:WORD_1
    v_rcp_f16_sdwa v85, v93 dst_sel:WORD_1 dst_unused:UNUSED_PRESERVE src0_sel:WORD_1
    v_pk_fma_f16 v80, v66, v84, v80
    v_pk_fma_f16 v81, v67, v85, v81
    s_cmp_eq_u32 s78, 13
    s_cbranch_scc1 K2_FL12
K2_BK12:
    ds_read_u16 v30, v109 offset:304
    s_waitcnt lgkmcnt(3)
    buffer_load_dwordx4 v[64:67], v[24:25], s[36:39], 0 idxen offen
    v_cvt_pk_f16_f32 v94, v49, v53
    v_cvt_pk_f16_f32 v95, v57, v61
    s_waitcnt vmcnt(3)
    v_pk_fma_f16 v92, v68, v94, v72
    v_pk_fma_f16 v93, v69, v95, v74
    v_rcp_f16 v84, v92
    v_rcp_f16 v85, v93
    v_rcp_f16_sdwa v84, v92 dst_sel:WORD_1 dst_unused:UNUSED_PRESERVE src0_sel:WORD_1
    v_rcp_f16_sdwa v85, v93 dst_sel:WORD_1 dst_unused:UNUSED_PRESERVE src0_sel:WORD_1
    v_pk_fma_f16 v80, v70, v84, v80
    v_pk_fma_f16 v81, v71, v85, v81
    s_cmp_eq_u32 s78, 14
    s_cbranch_scc1 K2_FL13
K2_BK13:
    ds_read_u16 v24, v109 offset:320
    s_waitcnt lgkmcnt(3)
    buffer_load_dwordx4 v[68:71], v[26:27], s[36:39], 0 idxen offen
    v_cvt_pk_f16_f32 v94, v50, v54
    v_cvt_pk_f16_f32 v95, v58, v62
    s_waitcnt vmcnt(3)
    v_pk_fma_f16 v92, v14, v94, v72
    v_pk_fma_f16 v93, v15, v95, v74
    v_rcp_f16 v84, v92
    v_rcp_f16 v85, v93
    v_rcp_f16_sdwa v84, v92 dst_sel:WORD_1 dst_unused:UNUSED_PRESERVE src0_sel:WORD_1
    v_rcp_f16_sdwa v85, v93 dst_sel:WORD_1 dst_unused:UNUSED_PRESERVE src0_sel:WORD_1
    v_pk_fma_f16 v80, v16, v84, v80
    v_pk_fma_f16 v81, v17, v85, v81
    s_cmp_eq_u32 s78, 15
    s_cbranch_scc1 K2_FL14
K2_BK14:
    ds_read_u16 v26, v109 offset:336
    s_waitcnt lgkmcnt(3)
    buffer_load_dwordx4 v[14:17], v[28:29], s[36:39], 0 idxen offen
    v_cvt_pk_f16_f32 v94, v51, v55
    v_cvt_pk_f16_f32 v95, v59, v63
    s_waitcnt vmcnt(3)
    v_pk_fma_f16 v92, v4, v94, v72
    v_pk_fma_f16 v93, v5, v95, v74
    v_rcp_f16 v84, v92
    v_rcp_f16 v85, v93
    v_rcp_f16_sdwa v84, v92 dst_sel:WORD_1 dst_unused:UNUSED_PRESERVE src0_sel:WORD_1
    v_rcp_f16_sdwa v85, v93 dst_sel:WORD_1 dst_unused:UNUSED_PRESERVE src0_sel:WORD_1
    v_pk_fma_f16 v80, v6, v84, v80
    v_pk_fma_f16 v81, v7, v85, v81
    s_cmp_eq_u32 s78, 16
    s_cbranch_scc1 K2_FL15
K2_BK15:
    v_add_u32 v109, 0x100, v109
    s_add_u32 s74, s74, 16
    s_sub_u32 s78, s78, 16
    s_sub_u32 s3, s75, s74
    s_cmp_gt_i32 s3, 24
    s_cbranch_scc1 K2_PRX
    s_setprio 2
    s_cmp_gt_i32 s3, 16
    s_cbranch_scc1 K2_PRX
    s_setprio 1
    s_cmp_gt_i32 s3, 8
    s_cbranch_scc1 K2_PRX
    s_setprio 0
K2_PRX:
    s_sub_u32 s3, s74, s76
    s_cmp_lt_u32 s3, 24
    s_cbranch_scc1 K2_LOOP
    s_sub_u32 s77, s74, 1
    s_nop 0
    v_permlane32_swap_b32 v80, v81
    s_nop 0
    v_fma_mix_f32 v100, v80, 1.0, v81 op_sel:[0,0,0] op_sel_hi:[1,0,1]
    v_fma_mix_f32 v101, v80, 1.0, v81 op_sel:[1,0,1] op_sel_hi:[1,0,1]
    v_mov_b64 v[80:81], 0
    s_nop 0
    v_permlane16_swap_b32 v100, v101
    s_nop 0
    v_add_f32 v100, v100, v101
    v_cmp_ngt_f32 vcc, s80, |v100|
    s_cbranch_vccnz K2_FSR
    s_waitcnt lgkmcnt(2)
    v_fma_mix_f32 v88, v100, v89, v88 op_sel_hi:[0,1,0]
K2_FJR:
    s_mov_b32 s76, s74
    s_branch K2_LOOP
K2_FSR:
    s_call_b64 s[34:35], K2_SLOW
    s_nop 1
    v_permlane32_swap_b32 v100, v102
    v_permlane32_swap_b32 v101, v103
    v_mov_b64 v[80:81], 0
    v_pk_add_f32 v[100:101], v[100:101], v[102:103]
    s_nop 1
    v_permlane16_swap_b32 v100, v101
    s_nop 0
    v_add_f32 v100, v100, v101
    s_waitcnt lgkmcnt(2)
    v_add_f32 v88, v100, v88
    s_branch K2_FJR
K2_FL0:
    s_call_b64 s[82:83], K2_FLUSH
    s_cbranch_scc0 K2_BK0
    s_branch K2_MAINDONE
K2_FL1:
    s_call_b64 s[82:83], K2_FLUSH
    s_cbranch_scc0 K2_BK1
    s_branch K2_MAINDONE
K2_FL2:
    s_call_b64 s[82:83], K2_FLUSH
    s_cbranch_scc0 K2_BK2
    s_branch K2_MAINDONE
K2_FL3:
    s_call_b64 s[82:83], K2_FLUSH
    s_cbranch_scc0 K2_BK3
    s_branch K2_MAINDONE
K2_FL4:
    s_call_b64 s[82:83], K2_FLUSH
    s_cbranch_scc0 K2_BK4
    s_branch K2_MAINDONE
K2_FL5:
    s_call_b64 s[82:83], K2_FLUSH
    s_cbranch_scc0 K2_BK5
    s_branch K2_MAINDONE
K2_FL6:
    s_call_b64 s[82:83], K2_FLUSH
    s_cbranch_scc0 K2_BK6
    s_branch K2_MAINDONE
K2_FL7:
    s_call_b64 s[82:83], K2_FLUSH
    s_cbranch_scc0 K2_BK7
    s_branch K2_MAINDONE
K2_FL8:
    s_call_b64 s[82:83], K2_FLUSH
    s_cbranch_scc0 K2_BK8
    s_branch K2_MAINDONE
K2_FL9:
    s_call_b64 s[82:83], K2_FLUSH
    s_cbranch_scc0 K2_BK9
    s_branch K2_MAINDONE
K2_FL10:
    s_call_b64 s[82:83], K2_FLUSH
    s_cbranch_scc0 K2_BK10
    s_branch K2_MAINDONE
K2_FL11:
    s_call_b64 s[82:83], K2_FLUSH
    s_cbranch_scc0 K2_BK11
    s_branch K2_MAINDONE
K2_FL12:
    s_call_b64 s[82:83], K2_FLUSH
    s_cbranch_scc0 K2_BK12
    s_branch K2_MAINDONE
K2_FL13:
    s_call_b64 s[82:83], K2_FLUSH
    s_cbranch_scc0 K2_BK13
    s_branch K2_MAINDONE
K2_FL14:
    s_call_b64 s[82:83], K2_FLUSH
    s_cbranch_scc0 K2_BK14
    s_branch K2_MAINDONE
K2_FL15:
    s_call_b64 s[82:83], K2_FLUSH
    s_cbranch_scc0 K2_BK15
    s_branch K2_MAINDONE
K2_FLUSH:
    s_ff1_i32_b64 s85, s[60:61]
    s_max_i32 s85, s85, 0
    s_mul_i32 s8, s85, 272
    v_add_u32 v113, s8, v2
    ds_read_b128 v[72:75], v113 offset:14336
    v_permlane32_swap_b32 v80, v81
    s_bitset0_b64 s[60:61], s85
    v_fma_mix_f32 v100, v80, 1.0, v81 op_sel:[0,0,0] op_sel_hi:[1,0,1]
    v_fma_mix_f32 v101, v80, 1.0, v81 op_sel:[1,0,1] op_sel_hi:[1,0,1]
    v_mov_b64 v[80:81], 0
    v_readlane_b32 s79, v18, s85
    v_permlane16_swap_b32 v100, v101
    s_add_u32 s77, s74, s78
    v_add_f32 v100, v100, v101
    s_sub_u32 s77, s77, 1
    v_cmp_ngt_f32 vcc, s80, |v100|
    s_cbranch_vccnz K2_FSF
    s_waitcnt lgkmcnt(2)
    v_fma_mix_f32 v100, v100, v89, v88 op_sel_hi:[0,1,0]
K2_FJF:
    s_cmp_lg_u32 s68, 0
    s_cbranch_scc1 K2_FAT
    ds_write_b32 v111, v100
K2_FAB:
    v_add_u32 v111, s8, v124
    ds_read2st64_b32 v[88:89], v111 offset0:0 offset1:56
    s_add_u32 s76, s77, 1
    s_min_u32 s78, s79, s75
    s_sub_u32 s78, s78, s74
    s_mov_b32 s81, s85
    s_waitcnt lgkmcnt(2)
    s_cmp_eq_u32 s76, s75
    s_setpc_b64 s[82:83]
K2_FAT:
    ds_add_f32 v111, v100
    s_mov_b32 s68, 0
    s_branch K2_FAB
K2_FSF:
    s_call_b64 s[34:35], K2_SLOW
    s_nop 1
    v_permlane32_swap_b32 v100, v102
    v_permlane32_swap_b32 v101, v103
    v_mov_b64 v[80:81], 0
    v_pk_add_f32 v[100:101], v[100:101], v[102:103]
    s_nop 1
    v_permlane16_swap_b32 v100, v101
    s_nop 0
    v_add_f32 v100, v100, v101
    s_waitcnt lgkmcnt(2)
    v_add_f32 v100, v100, v88
    s_branch K2_FJF
K2_GEMM:
    s_and_b32 s8, s7, 1
    s_lshl_b32 s8, s8, 5
    v_and_b32 v56, 31, v1
    v_lshrrev_b32 v57, 5, v1
    v_add_u32 v56, s8, v56
    v_mul_u32_u24 v58, 144, v56
    v_lshl_add_u32 v58, v57, 4, v58
    s_bfe_u32 s9, s7, 0x10001
    v_mul_u32_u24 v59, 272, v56
    v_lshl_add_u32 v59, v57, 6, v59
    s_lshl_b32 s9, s9, 7
    v_add_u32 v59, s9, v59
    v_cmp_gt_u32 s[12:13], 49, v56
    s_waitcnt vmcnt(0)
    v_and_b32 v23, 0xffff, v9
    v_lshrrev_b32 v5, 16, v9
    v_sub_u32 v23, v23, v6 clamp
    v_add_lshl_u32 v5, v5, v20, 4
    v_cmp_lt_u32 s[60:61], 0, v23
    v_cmp_lt_u32 s[66:67], 18, v23
    v_cmp_lt_u32 s[72:73], 36, v23
    v_cndmask_b32 v48, v51, v5, s[60:61]
    buffer_load_dwordx4 v[24:27], v48, s[40:43], 0 offen offset:0
    v_cndmask_b32 v49, v51, v5, s[66:67]
    buffer_load_dwordx4 v[28:31], v49, s[40:43], 0 offen offset:96
    buffer_load_dwordx4 v[64:67], v22, s[40:43], s5 offen offset:0
    buffer_load_dwordx4 v[68:71], v22, s[40:43], s5 offen offset:1024
    buffer_load_dwordx4 v[72:75], v22, s[40:43], s5 offen offset:2048
    buffer_load_dwordx4 v[76:79], v22, s[40:43], s5 offen offset:3072
    s_cmp_eq_u64 s[72:73], 0
    s_cbranch_scc1 K2_NOL2G
    v_cndmask_b32 v50, v51, v5, s[72:73]
    buffer_load_dwordx4 v[32:35], v50, s[40:43], 0 offen offset:192
K2_NOL2G:
    v_cmp_lt_u32 s[62:63], 1, v23
    v_cmp_lt_u32 s[64:65], 2, v23
    v_cmp_lt_u32 s[68:69], 19, v23
    v_cmp_lt_u32 s[70:71], 20, v23
    v_cmp_lt_u32 s[74:75], 37, v23
    v_cmp_lt_u32 s[76:77], 38, v23
    s_mov_b32 s8, 0x3fb8aa3b
    s_mov_b32 s9, 0x40851592
    s_waitcnt lgkmcnt(0)
    s_barrier
    ds_read_b128 v[96:99], v58 offset:48960
    ds_read_b128 v[100:103], v58 offset:48992
    ds_read_b128 v[104:107], v58 offset:49024
    ds_read_b128 v[108:111], v58 offset:49056
    s_waitcnt vmcnt(0)
    s_waitcnt lgkmcnt(3)
    v_mfma_f32_32x32x16_bf16 v[80:95], v[64:67], v[96:99], 0
    s_waitcnt lgkmcnt(2)
    v_mfma_f32_32x32x16_bf16 v[80:95], v[68:71], v[100:103], v[80:95]
    s_waitcnt lgkmcnt(1)
    v_mfma_f32_32x32x16_bf16 v[80:95], v[72:75], v[104:107], v[80:95]
    s_waitcnt lgkmcnt(0)
    v_mfma_f32_32x32x16_bf16 v[80:95], v[76:79], v[108:111], v[80:95]
    s_nop 7
    s_nop 2
    s_cmp_ge_u32 s7, 12
    s_nop 0
    s_cbranch_scc1 K2_GU
    v_max_f32 v60, |v80|, |v81|
    v_max3_f32 v60, v60, |v82|, |v83|
    v_max3_f32 v60, v60, |v84|, |v85|
    v_max3_f32 v60, v60, |v86|, |v87|
    v_max3_f32 v60, v60, |v88|, |v89|
    v_max3_f32 v60, v60, |v90|, |v91|
    v_max3_f32 v60, v60, |v92|, |v93|
    v_max3_f32 v60, v60, |v94|, |v95|
    v_fma_f32 v80, s8, v80, -4.0
    v_fma_f32 v81, s8, v81, -4.0
    v_fma_f32 v82, s8, v82, -4.0
    v_fma_f32 v83, s8, v83, -4.0
    v_fma_f32 v84, s8, v84, -4.0
    v_fma_f32 v85, s8, v85, -4.0
    v_fma_f32 v86, s8, v86, -4.0
    v_fma_f32 v87, s8, v87, -4.0
    v_fma_f32 v88, s8, v88, -4.0
    v_fma_f32 v89, s8, v89, -4.0
    v_fma_f32 v90, s8, v90, -4.0
    v_fma_f32 v91, s8, v91, -4.0
    v_fma_f32 v92, s8, v92, -4.0
    v_fma_f32 v93, s8, v93, -4.0
    v_fma_f32 v94, s8, v94, -4.0
    v_fma_f32 v95, s8, v95, -4.0
    v_cmp_ge_f32 vcc, s9, v60
    v_exp_f32 v80, v80
    v_exp_f32 v81, v81
    v_exp_f32 v82, v82
    v_exp_f32 v83, v83
    v_exp_f32 v84, v84
    v_exp_f32 v85, v85
    v_exp_f32 v86, v86
    v_exp_f32 v87, v87
    v_exp_f32 v88, v88
    v_exp_f32 v89, v89
    v_exp_f32 v90, v90
    v_exp_f32 v91, v91
    v_exp_f32 v92, v92
    v_exp_f32 v93, v93
    v_exp_f32 v94, v94
    v_exp_f32 v95, v95
    v_add_u32 v59, 14336, v59
    v_cvt_pk_f16_f32 v80, v80, v81
    v_cvt_pk_f16_f32 v82, v82, v83
    v_cvt_pk_f16_f32 v84, v84, v85
    v_cvt_pk_f16_f32 v86, v86, v87
    v_cvt_pk_f16_f32 v88, v88, v89
    v_cvt_pk_f16_f32 v90, v90, v91
    v_cvt_pk_f16_f32 v92, v92, v93
    v_cvt_pk_f16_f32 v94, v94, v95
    v_lshrrev_b32 v81, 16, v80
    v_lshrrev_b32 v83, 16, v82
    v_lshrrev_b32 v85, 16, v84
    v_lshrrev_b32 v87, 16, v86
    v_lshrrev_b32 v89, 16, v88
    v_lshrrev_b32 v91, 16, v90
    v_lshrrev_b32 v93, 16, v92
    v_lshrrev_b32 v95, 16, v94
    v_cndmask_b32 v80, -1, v80, vcc
K2_GU:
    s_mov_b64 exec, s[12:13]
    ds_write_b128 v59, v[80:83] offset:0
    ds_write_b128 v59, v[84:87] offset:16
    ds_write_b128 v59, v[88:91] offset:32
    ds_write_b128 v59, v[92:95] offset:48
K2_GV:
    s_mov_b64 exec, -1
    s_branch K2_RANK
K2_SLOW:
    s_mov_b32 s48, s28
    s_and_b32 s49, s29, 0xffff
    s_mov_b32 s50, 0x4080
    s_mov_b32 s51, 0x20000
    s_mov_b32 s52, s16
    s_and_b32 s53, s17, 0xffff
    s_mov_b32 s54, 0x186a00
    s_mov_b32 s55, 0x20000
    v_mov_b32 v100, 0
    v_mov_b32 v101, 0
    v_mov_b32 v102, 0
    v_mov_b32 v103, 0
    s_mov_b32 s84, s76
    s_mov_b32 s15, 0xbfb8aa3b
    v_lshrrev_b32 v122, 1, v2
K2_SLOWL:
    s_lshl_b32 s12, s84, 4
    s_add_u32 s12, s12, 31552
    v_add_u32 v118, s12, v112
    ds_read_b32 v120, v118
    s_movk_i32 s12, 0x4000
    buffer_load_dwordx2 v[80:81], v122, s[48:51], s12 offen
    v_mov_b32 v119, v2
    s_waitcnt lgkmcnt(0)
    v_and_b32 v118, 0xffff, v120
    v_and_b32 v121, 0xffff0000, v120
    v_lshlrev_b32 v123, 7, v118
    s_waitcnt vmcnt(0)
    v_lshlrev_b32 v92, 16, v80
    v_and_b32 v93, 0xffff0000, v80
    v_lshlrev_b32 v94, 16, v81
    v_and_b32 v95, 0xffff0000, v81
    v_mul_f32 v92, v92, v121
    v_mul_f32 v93, v93, v121
    v_mul_f32 v94, v94, v121
    v_mul_f32 v95, v95, v121
    v_mov_b64 v[96:97], 0
    v_mov_b64 v[98:99], 0
    s_mov_b32 s13, 0
K2_SLOWKS:
    buffer_load_dwordx2 v[120:121], v123, s[52:55], s13 offen
    s_lshl_b32 s14, s13, 6
    s_add_u32 s14, s14, 0x2000
    buffer_load_dwordx2 v[80:81], v122, s[48:51], s14 offen offset:0
    buffer_load_dwordx2 v[82:83], v122, s[48:51], s14 offen offset:128
    buffer_load_dwordx2 v[84:85], v122, s[48:51], s14 offen offset:256
    buffer_load_dwordx2 v[86:87], v122, s[48:51], s14 offen offset:384
    s_waitcnt vmcnt(0)
    v_lshlrev_b32 v104, 16, v120
    v_lshlrev_b32 v105, 16, v80
    v_fma_f32 v92, v104, v105, v92
    v_and_b32 v105, 0xffff0000, v80
    v_fma_f32 v93, v104, v105, v93
    v_lshlrev_b32 v105, 16, v81
    v_fma_f32 v94, v104, v105, v94
    v_and_b32 v105, 0xffff0000, v81
    v_fma_f32 v95, v104, v105, v95
    v_and_b32 v104, 0xffff0000, v120
    v_lshlrev_b32 v105, 16, v82
    v_fma_f32 v92, v104, v105, v92
    v_and_b32 v105, 0xffff0000, v82
    v_fma_f32 v93, v104, v105, v93
    v_lshlrev_b32 v105, 16, v83
    v_fma_f32 v94, v104, v105, v94
    v_and_b32 v105, 0xffff0000, v83
    v_fma_f32 v95, v104, v105, v95
    v_lshlrev_b32 v104, 16, v121
    v_lshlrev_b32 v105, 16, v84
    v_fma_f32 v92, v104, v105, v92
    v_and_b32 v105, 0xffff0000, v84
    v_fma_f32 v93, v104, v105, v93
    v_lshlrev_b32 v105, 16, v85
    v_fma_f32 v94, v104, v105, v94
    v_and_b32 v105, 0xffff0000, v85
    v_fma_f32 v95, v104, v105, v95
    v_and_b32 v104, 0xffff0000, v121
    v_lshlrev_b32 v105, 16, v86
    v_fma_f32 v92, v104, v105, v92
    v_and_b32 v105, 0xffff0000, v86
    v_fma_f32 v93, v104, v105, v93
    v_lshlrev_b32 v105, 16, v87
    v_fma_f32 v94, v104, v105, v94
    v_and_b32 v105, 0xffff0000, v87
    v_fma_f32 v95, v104, v105, v95
    s_add_u32 s13, s13, 8
    s_cmp_lt_u32 s13, 128
    s_cbranch_scc1 K2_SLOWKS
    s_mov_b32 s48, s26
    s_and_b32 s49, s27, 0xffff
    s_mov_b32 s50, 0x2000
    s_mov_b32 s51, 0x20000
    s_mov_b32 s13, 0
K2_SLOWKV:
    buffer_load_dwordx2 v[120:121], v123, s[52:55], s13 offen
    s_lshl_b32 s14, s13, 6
    buffer_load_dwordx2 v[80:81], v122, s[48:51], s14 offen offset:0
    buffer_load_dwordx2 v[82:83], v122, s[48:51], s14 offen offset:128
    buffer_load_dwordx2 v[84:85], v122, s[48:51], s14 offen offset:256
    buffer_load_dwordx2 v[86:87], v122, s[48:51], s14 offen offset:384
    s_waitcnt vmcnt(0)
    v_lshlrev_b32 v104, 16, v120
    v_lshlrev_b32 v105, 16, v80
    v_fma_f32 v96, v104, v105, v96
    v_and_b32 v105, 0xffff0000, v80
    v_fma_f32 v97, v104, v105, v97
    v_lshlrev_b32 v105, 16, v81
    v_fma_f32 v98, v104, v105, v98
    v_and_b32 v105, 0xffff0000, v81
    v_fma_f32 v99, v104, v105, v99
    v_and_b32 v104, 0xffff0000, v120
    v_lshlrev_b32 v105, 16, v82
    v_fma_f32 v96, v104, v105, v96
    v_and_b32 v105, 0xffff0000, v82
    v_fma_f32 v97, v104, v105, v97
    v_lshlrev_b32 v105, 16, v83
    v_fma_f32 v98, v104, v105, v98
    v_and_b32 v105, 0xffff0000, v83
    v_fma_f32 v99, v104, v105, v99
    v_lshlrev_b32 v104, 16, v121
    v_lshlrev_b32 v105, 16, v84
    v_fma_f32 v96, v104, v105, v96
    v_and_b32 v105, 0xffff0000, v84
    v_fma_f32 v97, v104, v105, v97
    v_lshlrev_b32 v105, 16, v85
    v_fma_f32 v98, v104, v105, v98
    v_and_b32 v105, 0xffff0000, v85
    v_fma_f32 v99, v104, v105, v99
    v_and_b32 v104, 0xffff0000, v121
    v_lshlrev_b32 v105, 16, v86
    v_fma_f32 v96, v104, v105, v96
    v_and_b32 v105, 0xffff0000, v86
    v_fma_f32 v97, v104, v105, v97
    v_lshlrev_b32 v105, 16, v87
    v_fma_f32 v98, v104, v105, v98
    v_and_b32 v105, 0xffff0000, v87
    v_fma_f32 v99, v104, v105, v99
    s_add_u32 s13, s13, 8
    s_cmp_lt_u32 s13, 128
    s_cbranch_scc1 K2_SLOWKV
    s_mov_b32 s48, s28
    s_and_b32 s49, s29, 0xffff
    s_mov_b32 s50, 0x4080
    s_mov_b32 s51, 0x20000
    s_mul_i32 s12, s2, 49
    s_add_u32 s12, s12, s81
    s_lshl_b32 s12, s12, 7
    v_mov_b32 v123, s12
    s_mov_b32 s13, 0
K2_SLOWKD:
    buffer_load_dwordx2 v[120:121], v123, s[52:55], s13 offen
    s_lshl_b32 s14, s13, 6
    buffer_load_dwordx2 v[80:81], v122, s[48:51], s14 offen offset:0
    buffer_load_dwordx2 v[82:83], v122, s[48:51], s14 offen offset:128
    buffer_load_dwordx2 v[84:85], v122, s[48:51], s14 offen offset:256
    buffer_load_dwordx2 v[86:87], v122, s[48:51], s14 offen offset:384
    s_waitcnt vmcnt(0)
    v_lshlrev_b32 v104, 16, v120
    v_lshlrev_b32 v105, 16, v80
    v_fma_f32 v92, v104, v105, v92
    v_and_b32 v105, 0xffff0000, v80
    v_fma_f32 v93, v104, v105, v93
    v_lshlrev_b32 v105, 16, v81
    v_fma_f32 v94, v104, v105, v94
    v_and_b32 v105, 0xffff0000, v81
    v_fma_f32 v95, v104, v105, v95
    v_and_b32 v104, 0xffff0000, v120
    v_lshlrev_b32 v105, 16, v82
    v_fma_f32 v92, v104, v105, v92
    v_and_b32 v105, 0xffff0000, v82
    v_fma_f32 v93, v104, v105, v93
    v_lshlrev_b32 v105, 16, v83
    v_fma_f32 v94, v104, v105, v94
    v_and_b32 v105, 0xffff0000, v83
    v_fma_f32 v95, v104, v105, v95
    v_lshlrev_b32 v104, 16, v121
    v_lshlrev_b32 v105, 16, v84
    v_fma_f32 v92, v104, v105, v92
    v_and_b32 v105, 0xffff0000, v84
    v_fma_f32 v93, v104, v105, v93
    v_lshlrev_b32 v105, 16, v85
    v_fma_f32 v94, v104, v105, v94
    v_and_b32 v105, 0xffff0000, v85
    v_fma_f32 v95, v104, v105, v95
    v_and_b32 v104, 0xffff0000, v121
    v_lshlrev_b32 v105, 16, v86
    v_fma_f32 v92, v104, v105, v92
    v_and_b32 v105, 0xffff0000, v86
    v_fma_f32 v93, v104, v105, v93
    v_lshlrev_b32 v105, 16, v87
    v_fma_f32 v94, v104, v105, v94
    v_and_b32 v105, 0xffff0000, v87
    v_fma_f32 v95, v104, v105, v95
    s_add_u32 s13, s13, 8
    s_cmp_lt_u32 s13, 128
    s_cbranch_scc1 K2_SLOWKD
    v_mul_f32 v92, s15, v92
    v_mul_f32 v93, s15, v93
    v_mul_f32 v94, s15, v94
    v_mul_f32 v95, s15, v95
    v_exp_f32 v92, v92
    v_exp_f32 v93, v93
    v_exp_f32 v94, v94
    v_exp_f32 v95, v95
    s_nop 0
    v_add_f32 v92, 1.0, v92
    v_add_f32 v93, 1.0, v93
    v_add_f32 v94, 1.0, v94
    v_add_f32 v95, 1.0, v95
    v_rcp_f32 v92, v92
    v_rcp_f32 v93, v93
    v_rcp_f32 v94, v94
    v_rcp_f32 v95, v95
    s_nop 0
    v_fma_f32 v100, v96, v92, v100
    v_fma_f32 v101, v97, v93, v101
    v_fma_f32 v102, v98, v94, v102
    v_fma_f32 v103, v99, v95, v103
    s_add_u32 s84, s84, 1
    s_cmp_le_u32 s84, s77
    s_cbranch_scc1 K2_SLOWL
    s_setpc_b64 s[34:35]
K2_R3X:
    s_waitcnt vmcnt(1)
    v_and_b32 v42, 0xff, v35
    v_bfe_u32 v43, v35, 8, 8
    v_bfe_u32 v44, v35, 16, 8
    s_mov_b64 exec, s[72:73]
    ds_add_rtn_u32 v42, v42, v4 offset:28480
    s_mov_b64 exec, s[74:75]
    ds_add_rtn_u32 v43, v43, v4 offset:28480
    s_mov_b64 exec, s[76:77]
    ds_add_rtn_u32 v44, v44, v4 offset:28480
    s_waitcnt lgkmcnt(0)
    s_mov_b64 exec, s[72:73]
    v_min_u32 v42, s11, v42
    ds_write_b32 v42, v32
    s_mov_b64 exec, s[74:75]
    v_min_u32 v43, s11, v43
    ds_write_b32 v43, v33
    s_mov_b64 exec, s[76:77]
    v_min_u32 v44, s11, v44
    ds_write_b32 v44, v34
    s_mov_b64 exec, -1
    v_cmpx_lt_u32 vcc, 54, v23
    v_mov_b32 v60, 0
    v_mov_b32 v61, 0x100000
    ds_write_b32 v60, v61 offset:28732
    s_mov_b64 exec, -1
    s_branch K2_NOR3X
K2_NOWORK:
    s_cmp_eq_u32 s69, 0
    s_cbranch_scc1 K2_MAINDONE
    s_waitcnt vmcnt(0) lgkmcnt(0)
    s_branch K2_XU
K2_GENERAL:
    s_mov_b32 s58, 1
    s_mov_b32 s56, -1
    s_branch K2_NEXTWIN
K2_MAINDONE:
    s_setprio 0
    s_waitcnt lgkmcnt(0)
    s_barrier
    s_cmp_lg_u32 s58, 0
    s_cbranch_scc1 K2_NEXTWIN
K2_LASTW2:
    s_cmp_gt_u32 s7, 12
    s_cbranch_scc1 K2_END
    ds_read_b128 v[24:27], v3 offset:0
    ds_read_b128 v[36:39], v3 offset:58176
    v_add_u32 v28, 72320, v3
    ds_read_b128 v[40:43], v28
K2_NOSP:
K2_EPI:
    s_mov_b32 s44, s30
    s_and_b32 s45, s31, 0xffff
    s_mov_b32 s46, 0x186a00
    s_mov_b32 s47, 0x20000
    s_mov_b32 s4, 0xbfb8aa3b
    s_mul_i32 s5, s2, 6272
    v_lshlrev_b32 v32, 3, v0
    v_cmp_gt_u32 vcc, 784, v0
    s_waitcnt lgkmcnt(0)
    v_pk_add_f32 v[24:25], v[24:25], v[36:37]
    v_pk_add_f32 v[26:27], v[26:27], v[38:39]
    v_pk_add_f32 v[24:25], v[24:25], v[40:41]
    v_pk_add_f32 v[26:27], v[26:27], v[42:43]
    v_mul_f32 v28, s4, v24
    v_mul_f32 v29, s4, v25
    v_mul_f32 v30, s4, v26
    v_mul_f32 v31, s4, v27
    v_exp_f32 v28, v28
    v_exp_f32 v29, v29
    v_exp_f32 v30, v30
    v_exp_f32 v31, v31
    s_nop 0
    v_add_f32 v28, 1.0, v28
    v_add_f32 v29, 1.0, v29
    v_add_f32 v30, 1.0, v30
    v_add_f32 v31, 1.0, v31
    v_rcp_f32 v28, v28
    v_rcp_f32 v29, v29
    v_rcp_f32 v30, v30
    v_rcp_f32 v31, v31
    s_nop 0
    v_mul_f32 v28, v24, v28
    v_mul_f32 v29, v25, v29
    v_mul_f32 v30, v26, v30
    v_mul_f32 v31, v27, v31
    v_cvt_pk_bf16_f32 v24, v28, v29
    v_cvt_pk_bf16_f32 v25, v30, v31
    s_mov_b64 exec, vcc
    buffer_store_dwordx2 v[24:25], v32, s[44:47], s5 offen sc1
K2_END:
    s_endpgm
K2_CONT:
    ds_write_b128 v3, v[24:27] offset:0
    s_waitcnt lgkmcnt(0)
K2_NOACC:
    s_cmp_eq_u32 s58, 0
    s_cbranch_scc1 K2_END
K2_NEXTWIN:
    s_add_u32 s56, s56, 1
    s_cmp_ge_u32 s56, 320
    s_cbranch_scc1 K2_LASTW2
    v_mov_b32 v4, 4
    v_mov_b32 v51, 0.5
    s_lshr_b32 s9, s56, 1
    s_and_b32 s10, s56, 1
    s_lshl_b32 s4, s9, 6
    v_mov_b32 v22, s4
    buffer_load_dword v9, v22, s[40:43], s57 offen
    s_mul_i32 s11, s10, 3072
    s_lshl_b32 s10, s10, 10
    s_waitcnt vmcnt(0)
    v_readfirstlane_b32 s4, v9
    s_and_b32 s5, s4, 0xffff
    s_cmp_le_u32 s5, s11
    s_cbranch_scc1 K2_NEXTWIN
    s_sub_u32 s5, s5, s11
    s_lshr_b32 s4, s4, 16
    s_mul_i32 s8, s9, 1840
    s_add_u32 s4, s4, s8
    s_add_u32 s4, s4, s10
    v_add_lshl_u32 v5, s4, v0, 4
    v_mul_u32_u24 v22, 3, v0
    v_sub_u32 v23, s5, v22 clamp
    v_cmp_lt_u32 s[60:61], 0, v23
    v_cmp_lt_u32 s[62:63], 1, v23
    v_cmp_lt_u32 s[64:65], 2, v23
K2_WINL:
    s_nop 1
    v_cndmask_b32 v48, v51, v5, s[60:61]
    buffer_load_dwordx4 v[24:27], v48, s[40:43], 0 offen
    s_barrier
    v_lshlrev_b32 v52, 2, v1
    v_mov_b32 v53, 0
    ds_write_b32 v52, v53 offset:28480
    s_waitcnt vmcnt(0) lgkmcnt(0)
    s_barrier
    v_and_b32 v36, 0xff, v27
    v_bfe_u32 v37, v27, 8, 8
    v_bfe_u32 v38, v27, 16, 8
    s_mov_b64 exec, s[60:61]
    ds_add_rtn_u32 v56, v36, v4 offset:28480
    s_mov_b64 exec, s[62:63]
    ds_add_rtn_u32 v57, v37, v4 offset:28480
    s_mov_b64 exec, s[64:65]
    ds_add_rtn_u32 v58, v38, v4 offset:28480
    s_mov_b64 exec, -1
    s_waitcnt lgkmcnt(0)
    s_barrier
    ds_read_b32 v53, v52 offset:28480
    s_waitcnt lgkmcnt(0)
    v_add_u32 v54, 12, v53
    v_lshrrev_b32 v54, 4, v54
    v_mov_b32 v18, v54
    s_nop 1
    v_add_u32_dpp v18, v18, v18 row_shr:1 row_mask:0xf bank_mask:0xf
    s_nop 1
    v_add_u32_dpp v18, v18, v18 row_shr:2 row_mask:0xf bank_mask:0xf
    s_nop 1
    v_add_u32_dpp v18, v18, v18 row_shr:4 row_mask:0xf bank_mask:0xf
    s_nop 1
    v_add_u32_dpp v18, v18, v18 row_shr:8 row_mask:0xf bank_mask:0xf
    s_nop 1
    v_add_u32_dpp v18, v18, v18 row_bcast:15 row_mask:0xa bank_mask:0xf
    s_nop 1
    v_add_u32_dpp v18, v18, v18 row_bcast:31 row_mask:0xc bank_mask:0xf
    v_cmp_ne_u32 s[10:11], 0, v54
    v_mov_b32 v20, 117056
    v_readlane_b32 s12, v18, 63
    v_sub_u32 v19, v18, v54
    v_lshl_add_u32 v55, v19, 4, v20
    ds_bpermute_b32 v64, v36, v55
    ds_bpermute_b32 v65, v37, v55
    ds_bpermute_b32 v66, v38, v55
    v_mov_b32 v62, 0x7b00
    v_add_u32 v63, v55, v53
    v_lshlrev_b32 v54, 4, v54
    v_sub_u32 v54, v54, v53
    s_waitcnt lgkmcnt(0)
    s_mov_b64 exec, s[60:61]
    v_add_u32 v64, v64, v56
    ds_write_b32 v64, v24
    s_mov_b64 exec, s[62:63]
    v_add_u32 v65, v65, v57
    ds_write_b32 v65, v25
    s_mov_b64 exec, s[64:65]
    v_add_u32 v66, v66, v58
    ds_write_b32 v66, v26
    s_mov_b64 exec, -1
    v_cmpx_lt_u32 vcc, 0, v54
    ds_write_b32 v63, v62 offset:0
    v_cmpx_lt_u32 vcc, 4, v54
    ds_write_b32 v63, v62 offset:4
    v_cmpx_lt_u32 vcc, 8, v54
    ds_write_b32 v63, v62 offset:8
    s_mov_b64 exec, -1
    s_mov_b64 s[60:61], s[10:11]
    s_waitcnt lgkmcnt(0)
    s_barrier
    s_branch K2_SETUP
K2_LASTWIN:
    s_cmp_gt_u32 s7, 12
    s_cbranch_scc1 K2_END
    ds_read_b128 v[24:27], v3 offset:0
    ds_read_b128 v[36:39], v3 offset:58176
    s_branch K2_EPI
.section .rodata,"a"
.p2align 6
.amdhsa_kernel k1_kernel
  .amdhsa_next_free_vgpr 112
  .amdhsa_next_free_sgpr 102
  .amdhsa_accum_offset 112
  .amdhsa_group_segment_fixed_size 0
  .amdhsa_kernarg_size 80
  .amdhsa_user_sgpr_count 2
  .amdhsa_user_sgpr_kernarg_segment_ptr 1
  .amdhsa_system_sgpr_workgroup_id_x 1
.end_amdhsa_kernel
.p2align 6
.amdhsa_kernel k2_kernel
  .amdhsa_next_free_vgpr 128
  .amdhsa_next_free_sgpr 102
  .amdhsa_accum_offset 128
  .amdhsa_group_segment_fixed_size 0
  .amdhsa_kernarg_size 80
  .amdhsa_user_sgpr_count 2
  .amdhsa_user_sgpr_kernarg_segment_ptr 1
  .amdhsa_system_sgpr_workgroup_id_x 1
.end_amdhsa_kernel
```
